```python
import torch

def _softmax(x, axis=-1):
    return torch.softmax(x, dim=axis)
def _gelu(x):
    return torch.nn.functional.gelu(x, approximate="tanh")
def _silu(x):
    return torch.nn.functional.silu(x)
def _sigmoid(x):
    return torch.sigmoid(x)
def _layernorm(x, axis=-1, eps=1e-5):
    m = x.mean(dim=axis, keepdim=True)
    v = x.var(dim=axis, keepdim=True, unbiased=False)
    return (x - m) / torch.sqrt(v + eps)
def _scatter_add(tgt, idx, src, axis=0):
    return tgt.clone().index_add_(axis, idx, src)
def _segment_sum(src, seg, n):
    out = torch.zeros((n,) + src.shape[1:], dtype=src.dtype)
    return out.index_add_(0, seg, src)
def _pad(x, pw):
    flat = tuple(v for pair in reversed(pw) for v in pair)
    return torch.nn.functional.pad(x, flat)

kernel_name = 'concat_heads__spectral_fnet__linear_kernel_hedgehog__prompt'

def setup_inputs():

    _w = (lambda a: (lambda t: t.to(torch.bfloat16) if t.is_floating_point() else t)(torch.as_tensor(a)))
    def _A_setup():
        B, S, D = 1, 2048, 448
        ns = torch.arange(S)[:, None] * torch.arange(S)[None, :]
        nd = torch.arange(D)[:, None] * torch.arange(D)[None, :]
        Ws_re = torch.cos(-2.0 * torch.pi * ns / S).to(float)
        Ws_im = torch.sin(-2.0 * torch.pi * ns / S).to(float)
        Wd_re = torch.cos(-2.0 * torch.pi * nd / D).to(float)
        Wd_im = torch.sin(-2.0 * torch.pi * nd / D).to(float)
        return {
            "x": _w((lambda *s: torch.randn(*s, dtype=torch.bfloat16) * 0.05)(B, S, D)),
            "dft_seq_re": _w(Ws_re),
            "dft_seq_im": _w(Ws_im),
            "dft_hid_re": _w(Wd_re),
            "dft_hid_im": _w(Wd_im),
        }
    _A_in = _A_setup()

    def _B_setup():
        B, S, D, H = 1, 2048, 448, 16
        Dh = D // H
        return {
            "x": _w((lambda *s: torch.randn(*s, dtype=torch.bfloat16) * 0.2)(B, S, D)),
            "wqkv": _w((lambda *s: torch.randn(*s, dtype=torch.bfloat16) * 1.6)(D, 3 * D)),
            "w_phi": _w((lambda *s: torch.randn(*s, dtype=torch.bfloat16) * 1.6)(H, Dh, Dh) * (Dh ** -0.5)),
            "wo": _w((lambda *s: torch.randn(*s, dtype=torch.bfloat16) * 0.8)(D, D)),
        }
    _B_in = _B_setup()

    return {
        "A_x": _A_in["x"],
        "A_dft_seq_re": _A_in["dft_seq_re"],
        "A_dft_seq_im": _A_in["dft_seq_im"],
        "A_dft_hid_re": _A_in["dft_hid_re"],
        "A_dft_hid_im": _A_in["dft_hid_im"],
        "B_x": _B_in["x"],
        "B_wqkv": _B_in["wqkv"],
        "B_w_phi": _B_in["w_phi"],
        "B_wo": _B_in["wo"],
    }

def reference(A_x, A_dft_seq_re, A_dft_seq_im, A_dft_hid_re, A_dft_hid_im, B_x, B_wqkv, B_w_phi, B_wo):
    def _A_ref(x, dft_seq_re, dft_seq_im, dft_hid_re, dft_hid_im):
        a = torch.einsum("bsd,ed->bse", x, dft_hid_re)
        b = torch.einsum("bsd,ed->bse", x, dft_hid_im)
        y = torch.einsum("ts,bse->bte", dft_seq_re, a) - torch.einsum("ts,bse->bte", dft_seq_im, b)
        return y

    def _B_ref(x, wqkv, w_phi, wo):
        B, S, D = x.shape
        H = 16; Dh = D // H
        qkv = (lambda x, *d: x.permute(*d))((x @ wqkv).reshape(B, S, 3, H, Dh), 2, 0, 3, 1, 4)
        q, k, v = qkv[0], qkv[1], qkv[2]
        pq = torch.einsum("bhsd,hdf->bhsf", q, w_phi)
        pk = torch.einsum("bhsd,hdf->bhsf", k, w_phi)
        phi_q = torch.concatenate([_softmax(pq, axis=-1), _softmax(-pq, axis=-1)], axis=-1)
        phi_k = torch.concatenate([_softmax(pk, axis=-1), _softmax(-pk, axis=-1)], axis=-1)
        kv = torch.einsum("bhsf,bhsd->bhfd", phi_k, v)
        z  = torch.einsum("bhsf->bhf", phi_k)
        num = torch.einsum("bhqf,bhfd->bhqd", phi_q, kv)
        den = torch.einsum("bhqf,bhf->bhq", phi_q, z)[..., None] + 1e-6
        o = num / den
        return (lambda x, *d: x.permute(*d))(o, 0, 2, 1, 3).reshape(B, S, D) @ wo

    a = _A_ref(A_x, A_dft_seq_re, A_dft_seq_im, A_dft_hid_re, A_dft_hid_im)
    b = _B_ref(B_x, B_wqkv, B_w_phi, B_wo)
    return torch.concatenate([a, b], axis=-1)
```

```asm
; @launch kernel=k1_kernel grid=(256,1,1) block=(512,1,1) lds=163840
; @launch kernel=k2_kernel grid=(256,1,1) block=(512,1,1) lds=163840
.amdgcn_target "amdgcn-amd-amdhsa--gfx950"
.text
.globl k1_kernel
.p2align 8
.type k1_kernel,@function
k1_kernel:
    s_cmp_ge_u32 s2, 256
    s_cbranch_scc1 K1_END
    s_load_dwordx8 s[8:15], s[0:1], 40
    s_load_dwordx4 s[16:19], s[0:1], 80
    s_load_dwordx2 s[4:5], s[0:1], 0
    s_load_dwordx2 s[6:7], s[0:1], 72
    v_and_b32 v1, 63, v0
    v_lshrrev_b32 v2, 6, v0
    s_and_b32 s41, s2, 7
    s_lshr_b32 s42, s2, 3
    v_readfirstlane_b32 s40, v2
    s_cmp_ge_u32 s42, 24
    s_cbranch_scc1 K1_A
    s_and_b32 s43, s42, 1
    s_lshl_b32 s50, s41, 1
    s_add_u32 s43, s43, s50
    s_lshr_b32 s50, s42, 1
    s_and_b32 s50, s50, 7
    s_lshr_b32 s44, s42, 4
    s_add_u32 s53, s44, 1
    s_lshl_b32 s49, s50, s53
    s_cmp_eq_u32 s44, 1
    s_mov_b32 s46, 896
    s_cmov_b32 s46, 112
    s_mov_b32 s51, 112
    s_cmov_b32 s51, 224
    s_cselect_b32 s52, 0, 896
    s_mul_i32 s45, s50, s51
    s_add_u32 s45, s45, s52
    v_lshrrev_b32 v3, 3, v1
    v_lshrrev_b32 v4, 4, v1
    v_and_b32 v5, 7, v1
    v_xor_b32 v6, v5, v4
    v_lshlrev_b32 v6, 4, v6
    v_mul_u32_u24 v7, 896, v3
    v_add_u32 v16, v7, v6
    v_xor_b32 v17, 64, v16
    v_add_u32 v17, 7168, v17
    v_and_b32 v4, 1, v4
    v_lshlrev_b32 v4, 2, v4
    v_xor_b32 v5, v5, v4
    v_min_u32 v5, 6, v5
    v_mul_u32_u24 v7, 2688, v3
    v_lshl_add_u32 v18, v5, 4, v7
    v_lshlrev_b32 v3, 4, v0
    s_lshl_b32 s54, s43, 3
    s_add_u32 s54, s54, s40
    s_mul_i32 s54, s54, 14336
    s_mul_i32 s62, s40, 21504
    s_add_u32 s62, s62, s45
    s_lshl_b32 s56, s40, 11
    s_lshl_b32 s61, s40, 10
    s_mul_i32 s57, s49, 1568
    s_add_u32 m0, s61, 155648
    s_min_u32 s58, s41, 6
    s_nop 0
    s_lshl_b32 s60, s58, 7
    s_add_u32 s54, s54, s60
    s_mul_i32 s55, s58, 172032
    s_add_u32 s55, s55, s62
    s_add_u32 s59, s55, s46
    s_mov_b32 s63, s58
    s_add_u32 s47, s62, s46
    s_mov_b32 s22, 0x1c0000
    s_mov_b32 s23, 0x20000
    s_mov_b32 s26, 0x126000
    s_mov_b32 s27, 0x20000
    s_mov_b32 s30, 0x6200
    s_mov_b32 s31, 0x20000
    s_waitcnt lgkmcnt(0)
    s_mov_b64 s[20:21], s[8:9]
    s_mov_b64 s[24:25], s[10:11]
    s_mov_b64 s[28:29], s[12:13]
    buffer_load_dwordx4 v3, s[28:31], s57 offen lds
    s_add_u32 m0, s56, 0
    s_add_u32 s58, s58, 1
    buffer_load_dwordx4 v16, s[20:23], s54 offen  lds
    s_add_u32 m0, s61, 16384
    s_cmp_eq_u32 s58, 7
    buffer_load_dwordx4 v18, s[24:27], s55 offen lds
    s_mov_b32 s60, 128
    s_cmov_b32 s60, 4294966528
    s_mov_b32 s64, 172032
    s_cmov_b32 s64, 4293935104
    s_add_u32 m0, s56, 1024
    s_add_u32 s55, s55, s64
    buffer_load_dwordx4 v17, s[20:23], s54 offen  lds
    s_add_u32 s54, s54, s60
    v_and_b32 v3, 3, v2
    v_and_b32 v4, 31, v1
    v_lshl_add_u32 v8, v3, 5, v4
    v_lshrrev_b32 v9, 5, v1
    v_bfe_u32 v5, v8, 1, 3
    v_xor_b32 v5, v5, v9
    v_lshlrev_b32 v5, 4, v5
    v_lshl_add_u32 v10, v8, 7, v5
    v_bfe_u32 v3, v1, 4, 1
    v_and_b32 v4, 3, v1
    v_lshl_add_u32 v3, v3, 2, v4
    v_min_u32 v3, 6, v3
    v_lshlrev_b32 v7, 3, v3
    v_lshrrev_b32 v2, 2, v2
    v_mad_u32_u24 v3, v2, 56, v7
    v_bfe_u32 v0, v1, 2, 2
    v_lshl_add_u32 v5, v9, 3, v0
    v_lshlrev_b32 v5, 7, v5
    v_bfe_u32 v4, v1, 3, 1
    v_lshlrev_b32 v4, 6, v4
    v_xor_b32 v6, v3, v4
    v_add_u32 v5, v5, v6
    v_add_u32 v14, 16384, v5
    v_add_u32 v15, 98304, v5
    v_lshl_add_u32 v4, v9, 2, v0
    v_mul_u32_u24 v4, 56, v4
    v_mul_u32_u24 v5, 1568, v2
    v_add3_u32 v3, v7, v4, v5
    v_add_u32 v19, 155648, v3
    v_xor_b32 v11, 32, v10
    v_xor_b32 v12, 64, v10
    v_xor_b32 v13, 96, v10
    s_mov_b32 s36, s16
    s_mov_b32 s37, s17
    s_mov_b32 s38, 0x100
    s_mov_b32 s39, 0x20000
    s_cmp_eq_u32 s44, 1
    s_cselect_b32 s60, 0, 4194304
    s_mov_b32 s34, 57344
    s_cmov_b32 s34, 3670016
    s_add_u32 s32, s18, s60
    s_addc_u32 s33, s19, 0
    s_mov_b32 s35, 0x20000
    s_and_b32 s65, s40, 3
    s_lshl_b32 s66, s43, 2
    s_add_u32 s65, s65, s66
    s_lshl_b32 s65, s65, 4
    s_lshr_b32 s66, s40, 2
    s_lshl_b32 s67, s66, 1
    s_add_u32 s65, s65, s67
    s_add_u32 s65, s65, s49
    s_mul_i32 s65, s65, 3584
    v_lshlrev_b32 v20, 4, v1
    s_mul_i32 s67, s66, 24576
    v_mul_u32_u24 v3, 192, v8
    v_bfe_u32 v4, v8, 1, 2
    v_lshlrev_b32 v5, 1, v9
    v_xor_b32 v4, v4, v5
    v_lshl_add_u32 v3, v4, 4, v3
    v_add_u32 v22, s67, v3
    v_xor_b32 v23, 16, v22
    s_mov_b32 s68, 0x3fb8aa3b
    s_lshr_b32 s66, s40, 2
    s_and_b32 s67, s40, 1
    s_mul_i32 s71, s66, 24576
    s_lshl_b32 s69, s67, 6
    v_lshl_add_u32 v4, v9, 3, v0
    v_mul_u32_u24 v4, 192, v4
    v_and_b32 v5, 1, v1
    v_bfe_u32 v6, v1, 4, 1
    v_lshl_add_u32 v5, v5, 1, v6
    v_lshrrev_b32 v3, 1, v0
    v_xor_b32 v5, v5, v3
    v_lshl_add_u32 v4, v5, 4, v4
    v_bfe_u32 v5, v1, 1, 1
    v_lshl_add_u32 v4, v5, 3, v4
    v_add_u32 v4, s71, v4
    v_xor_b32 v5, 32, v4
    v_add_u32 v6, s69, v4
    v_add_u32 v7, s69, v5
    s_and_b32 s71, s50, 2
    s_add_u32 s71, s71, s66
    s_lshl_b32 s71, s71, 1
    s_lshr_b32 s69, s50, 2
    s_add_u32 s71, s71, s69
    s_lshl_b32 s71, s71, 1
    s_and_b32 s69, s50, 1
    s_add_u32 s71, s71, s69
    s_mul_i32 s71, s71, 3584
    s_lshl_b32 s69, s67, 11
    s_add_u32 s71, s71, s69
    v_lshlrev_b32 v3, 2, v1
    s_and_b32 s48, s40, 2
    s_or_b32 s48, s48, s44
    v_mov_b32 v2, 0x3f80
    s_add_u32 m0, s56, 24576
    s_add_u32 s58, s58, 1
    buffer_load_dwordx4 v16, s[20:23], s54 offen  lds
    s_add_u32 m0, s61, 40960
    s_cmp_eq_u32 s58, 7
    buffer_load_dwordx4 v18, s[24:27], s55 offen lds
    s_mov_b32 s60, 128
    s_cmov_b32 s60, 4294966528
    s_mov_b32 s64, 172032
    s_cmov_b32 s64, 4293935104
    s_add_u32 m0, s56, 25600
    s_add_u32 s55, s55, s64
    buffer_load_dwordx4 v17, s[20:23], s54 offen  lds
    s_add_u32 s54, s54, s60
    s_waitcnt vmcnt(3) lgkmcnt(0)
    s_barrier
    s_add_u32 m0, s56, 49152
    s_add_u32 s58, s58, 1
    buffer_load_dwordx4 v16, s[20:23], s54 offen  lds
    ds_read_b128 v[144:147], v10
    ds_read_b64_tr_b16 v[32:33], v14 offset:0
    ds_read_b64_tr_b16 v[34:35], v14 offset:512
    ds_read_b128 v[148:151], v11
    ds_read_b64_tr_b16 v[36:37], v14 offset:2048
    s_add_u32 m0, s61, 65536
    s_cmp_eq_u32 s58, 7
    buffer_load_dwordx4 v18, s[24:27], s55 offen lds
    s_mov_b32 s60, 128
    s_cmov_b32 s60, 4294966528
    s_mov_b32 s64, 172032
    s_cmov_b32 s64, 4293935104
    ds_read_b64_tr_b16 v[38:39], v14 offset:2560
    ds_read_b128 v[152:155], v12
    ds_read_b64_tr_b16 v[40:41], v14 offset:4096
    ds_read_b64_tr_b16 v[42:43], v14 offset:4608
    ds_read_b128 v[156:159], v13
    s_add_u32 m0, s56, 50176
    s_add_u32 s55, s55, s64
    buffer_load_dwordx4 v17, s[20:23], s54 offen  lds
    s_add_u32 s54, s54, s60
    ds_read_b64_tr_b16 v[44:45], v14 offset:6144
    ds_read_b64_tr_b16 v[46:47], v14 offset:6656
    ds_read_b64_tr_b16 v[96:97], v19 offset:0
    ds_read_b64_tr_b16 v[98:99], v19 offset:448
    ds_read_b64_tr_b16 v[100:101], v19 offset:896
    ds_read_b64_tr_b16 v[102:103], v19 offset:1344
    ds_read_b64_tr_b16 v[104:105], v19 offset:3136
    ds_read_b64_tr_b16 v[106:107], v19 offset:3584
    ds_read_b64_tr_b16 v[108:109], v19 offset:4032
    ds_read_b64_tr_b16 v[110:111], v19 offset:4480
    v_add_u32 v10, 24576, v10
    v_add_u32 v11, 24576, v11
    v_add_u32 v12, 24576, v12
    v_add_u32 v13, 24576, v13
    v_add_u32 v14, 24576, v14
    s_waitcnt vmcnt(3) lgkmcnt(0)
    s_barrier
    v_mfma_f32_32x32x16_bf16 v[64:79], v[32:35], v[144:147], 0
    s_add_u32 m0, s56, 73728
    s_add_u32 s58, s58, 1
    buffer_load_dwordx4 v16, s[20:23], s54 offen  lds
    ds_read_b128 v[160:163], v10
    ds_read_b64_tr_b16 v[48:49], v14 offset:0
    ds_read_b64_tr_b16 v[50:51], v14 offset:512
    v_mfma_f32_32x32x16_bf16 v[64:79], v[36:39], v[148:151], v[64:79]
    s_add_u32 m0, s61, 90112
    s_cmp_eq_u32 s58, 7
    buffer_load_dwordx4 v18, s[24:27], s55 offen lds
    s_mov_b32 s60, 128
    s_cmov_b32 s60, 4294966528
    s_mov_b32 s64, 172032
    s_cmov_b32 s64, 4293935104
    ds_read_b128 v[164:167], v11
    ds_read_b64_tr_b16 v[52:53], v14 offset:2048
    ds_read_b64_tr_b16 v[54:55], v14 offset:2560
    v_mfma_f32_32x32x16_bf16 v[64:79], v[40:43], v[152:155], v[64:79]
    s_add_u32 m0, s56, 74752
    s_add_u32 s55, s55, s64
    buffer_load_dwordx4 v17, s[20:23], s54 offen  lds
    s_add_u32 s54, s54, s60
    ds_read_b128 v[168:171], v12
    ds_read_b64_tr_b16 v[56:57], v14 offset:4096
    ds_read_b64_tr_b16 v[58:59], v14 offset:4608
    v_mfma_f32_32x32x16_bf16 v[64:79], v[44:47], v[156:159], v[64:79]
    ds_read_b128 v[172:175], v13
    ds_read_b64_tr_b16 v[60:61], v14 offset:6144
    ds_read_b64_tr_b16 v[62:63], v14 offset:6656
    v_mov_b32 v24, 163832
    v_mov_b64 v[26:27], 0
    ds_write_b64 v24, v[26:27]
    v_add_u32 v10, 24576, v10
    v_add_u32 v11, 24576, v11
    v_add_u32 v12, 24576, v12
    v_add_u32 v13, 24576, v13
    v_add_u32 v14, 24576, v14
    s_waitcnt vmcnt(3) lgkmcnt(0)
    s_barrier
    v_mfma_f32_32x32x16_bf16 v[64:79], v[48:51], v[160:163], v[64:79]
    s_add_u32 m0, s56, 0
    s_add_u32 s58, s58, 1
    buffer_load_dwordx4 v16, s[20:23], s54 offen  lds
    ds_read_b128 v[176:179], v10
    ds_read_b64_tr_b16 v[32:33], v14 offset:0
    ds_read_b64_tr_b16 v[34:35], v14 offset:512
    v_mfma_f32_32x32x16_bf16 v[64:79], v[52:55], v[164:167], v[64:79]
    s_add_u32 m0, s61, 16384
    s_cmp_eq_u32 s58, 7
    buffer_load_dwordx4 v18, s[24:27], s55 offen lds
    s_mov_b32 s60, 128
    s_cmov_b32 s60, 4294966528
    s_mov_b32 s64, 172032
    s_cmov_b32 s64, 4293935104
    ds_read_b128 v[180:183], v11
    ds_read_b64_tr_b16 v[36:37], v14 offset:2048
    ds_read_b64_tr_b16 v[38:39], v14 offset:2560
    v_mfma_f32_32x32x16_bf16 v[64:79], v[56:59], v[168:171], v[64:79]
    s_add_u32 m0, s56, 1024
    s_add_u32 s55, s55, s64
    buffer_load_dwordx4 v17, s[20:23], s54 offen  lds
    s_add_u32 s54, s54, s60
    ds_read_b128 v[184:187], v12
    ds_read_b64_tr_b16 v[40:41], v14 offset:4096
    ds_read_b64_tr_b16 v[42:43], v14 offset:4608
    v_mfma_f32_32x32x16_bf16 v[64:79], v[60:63], v[172:175], v[64:79]
    ds_read_b128 v[188:191], v13
    ds_read_b64_tr_b16 v[44:45], v14 offset:6144
    ds_read_b64_tr_b16 v[46:47], v14 offset:6656
    v_add_u32 v10, 24576, v10
    v_add_u32 v11, 24576, v11
    v_add_u32 v12, 24576, v12
    v_add_u32 v13, 24576, v13
    v_add_u32 v14, 24576, v14
    s_waitcnt vmcnt(3) lgkmcnt(0)
    s_barrier
    v_mfma_f32_32x32x16_bf16 v[64:79], v[32:35], v[176:179], v[64:79]
    s_add_u32 m0, s56, 24576
    s_add_u32 s58, s58, 1
    buffer_load_dwordx4 v16, s[20:23], s54 offen  lds
    ds_read_b128 v[192:195], v10
    ds_read_b64_tr_b16 v[48:49], v14 offset:0
    ds_read_b64_tr_b16 v[50:51], v14 offset:512
    v_mfma_f32_32x32x16_bf16 v[64:79], v[36:39], v[180:183], v[64:79]
    s_add_u32 m0, s61, 40960
    s_cmp_eq_u32 s58, 7
    buffer_load_dwordx4 v18, s[24:27], s55 offen lds
    s_mov_b32 s60, 128
    s_cmov_b32 s60, 4294966528
    s_mov_b32 s64, 172032
    s_cmov_b32 s64, 4293935104
    ds_read_b128 v[196:199], v11
    ds_read_b64_tr_b16 v[52:53], v14 offset:2048
    ds_read_b64_tr_b16 v[54:55], v14 offset:2560
    v_mfma_f32_32x32x16_bf16 v[64:79], v[40:43], v[184:187], v[64:79]
    s_add_u32 m0, s56, 25600
    s_add_u32 s55, s55, s64
    buffer_load_dwordx4 v17, s[20:23], s54 offen  lds
    s_add_u32 s54, s54, s60
    ds_read_b128 v[200:203], v12
    ds_read_b64_tr_b16 v[56:57], v14 offset:4096
    ds_read_b64_tr_b16 v[58:59], v14 offset:4608
    v_mfma_f32_32x32x16_bf16 v[64:79], v[44:47], v[188:191], v[64:79]
    ds_read_b128 v[204:207], v13
    ds_read_b64_tr_b16 v[60:61], v14 offset:6144
    ds_read_b64_tr_b16 v[62:63], v14 offset:6656
    v_add_u32 v10, 4294893568, v10
    v_add_u32 v11, 4294893568, v11
    v_add_u32 v12, 4294893568, v12
    v_add_u32 v13, 4294893568, v13
    v_add_u32 v14, 4294893568, v14
    s_waitcnt vmcnt(3) lgkmcnt(0)
    s_barrier
    v_mfma_f32_32x32x16_bf16 v[64:79], v[48:51], v[192:195], v[64:79]
    s_add_u32 m0, s56, 49152
    s_add_u32 s58, s58, 1
    buffer_load_dwordx4 v16, s[20:23], s54 offen  lds
    ds_read_b128 v[208:211], v10
    ds_read_b64_tr_b16 v[32:33], v14 offset:0
    ds_read_b64_tr_b16 v[34:35], v14 offset:512
    v_mfma_f32_32x32x16_bf16 v[64:79], v[52:55], v[196:199], v[64:79]
    s_add_u32 m0, s61, 65536
    s_cmp_eq_u32 s58, 7
    buffer_load_dwordx4 v18, s[24:27], s55 offen lds
    s_mov_b32 s60, 128
    s_cmov_b32 s60, 4294966528
    s_mov_b32 s64, 172032
    s_cmov_b32 s64, 4293935104
    ds_read_b128 v[212:215], v11
    ds_read_b64_tr_b16 v[36:37], v14 offset:2048
    ds_read_b64_tr_b16 v[38:39], v14 offset:2560
    v_mfma_f32_32x32x16_bf16 v[64:79], v[56:59], v[200:203], v[64:79]
    s_add_u32 m0, s56, 50176
    s_add_u32 s55, s55, s64
    buffer_load_dwordx4 v17, s[20:23], s54 offen  lds
    s_add_u32 s54, s54, s60
    ds_read_b128 v[216:219], v12
    ds_read_b64_tr_b16 v[40:41], v14 offset:4096
    ds_read_b64_tr_b16 v[42:43], v14 offset:4608
    v_mfma_f32_32x32x16_bf16 v[64:79], v[60:63], v[204:207], v[64:79]
    ds_read_b128 v[220:223], v13
    ds_read_b64_tr_b16 v[44:45], v14 offset:6144
    ds_read_b64_tr_b16 v[46:47], v14 offset:6656
    v_add_u32 v10, 24576, v10
    v_add_u32 v11, 24576, v11
    v_add_u32 v12, 24576, v12
    v_add_u32 v13, 24576, v13
    v_add_u32 v14, 24576, v14
    s_waitcnt vmcnt(3) lgkmcnt(0)
    s_barrier
    v_mfma_f32_32x32x16_bf16 v[64:79], v[32:35], v[208:211], v[64:79]
    s_add_u32 m0, s61, 98304
    s_add_u32 s63, s63, 1
    buffer_load_dwordx4 v18, s[24:27], s59 offen lds
    s_add_u32 s59, s59, 172032
    s_cmp_eq_u32 s63, 7
    s_cselect_b32 s59, s47, s59
    ds_read_b128 v[224:227], v10
    ds_read_b64_tr_b16 v[48:49], v14 offset:0
    ds_read_b64_tr_b16 v[50:51], v14 offset:512
    v_mfma_f32_32x32x16_bf16 v[64:79], v[36:39], v[212:215], v[64:79]
    s_add_u32 m0, s61, 106496
    s_add_u32 s63, s63, 1
    buffer_load_dwordx4 v18, s[24:27], s59 offen lds
    s_add_u32 s59, s59, 172032
    s_cmp_eq_u32 s63, 7
    s_cselect_b32 s59, s47, s59
    ds_read_b128 v[228:231], v11
    ds_read_b64_tr_b16 v[52:53], v14 offset:2048
    ds_read_b64_tr_b16 v[54:55], v14 offset:2560
    v_mfma_f32_32x32x16_bf16 v[64:79], v[40:43], v[216:219], v[64:79]
    s_add_u32 m0, s61, 114688
    s_add_u32 s63, s63, 1
    buffer_load_dwordx4 v18, s[24:27], s59 offen lds
    s_add_u32 s59, s59, 172032
    s_cmp_eq_u32 s63, 7
    s_cselect_b32 s59, s47, s59
    ds_read_b128 v[232:235], v12
    ds_read_b64_tr_b16 v[56:57], v14 offset:4096
    ds_read_b64_tr_b16 v[58:59], v14 offset:4608
    v_mfma_f32_32x32x16_bf16 v[64:79], v[44:47], v[220:223], v[64:79]
    s_add_u32 m0, s61, 122880
    s_add_u32 s63, s63, 1
    buffer_load_dwordx4 v18, s[24:27], s59 offen lds
    s_add_u32 s59, s59, 172032
    s_cmp_eq_u32 s63, 7
    s_cselect_b32 s59, s47, s59
    ds_read_b128 v[236:239], v13
    ds_read_b64_tr_b16 v[60:61], v14 offset:6144
    ds_read_b64_tr_b16 v[62:63], v14 offset:6656
    v_add_u32 v10, 24576, v10
    v_add_u32 v11, 24576, v11
    v_add_u32 v12, 24576, v12
    v_add_u32 v13, 24576, v13
    v_add_u32 v14, 24576, v14
    s_waitcnt vmcnt(4) lgkmcnt(0)
    s_barrier
    v_mfma_f32_32x32x16_bf16 v[64:79], v[48:51], v[224:227], v[64:79]
    s_add_u32 m0, s61, 131072
    s_add_u32 s63, s63, 1
    buffer_load_dwordx4 v18, s[24:27], s59 offen lds
    s_add_u32 s59, s59, 172032
    s_cmp_eq_u32 s63, 7
    s_cselect_b32 s59, s47, s59
    ds_read_b128 v[240:243], v10
    ds_read_b64_tr_b16 v[32:33], v14 offset:0
    ds_read_b64_tr_b16 v[34:35], v14 offset:512
    v_mfma_f32_32x32x16_bf16 v[64:79], v[52:55], v[228:231], v[64:79]
    s_add_u32 m0, s61, 139264
    s_add_u32 s63, s63, 1
    buffer_load_dwordx4 v18, s[24:27], s59 offen lds
    s_add_u32 s59, s59, 172032
    s_cmp_eq_u32 s63, 7
    s_cselect_b32 s59, s47, s59
    ds_read_b128 v[244:247], v11
    ds_read_b64_tr_b16 v[36:37], v14 offset:2048
    ds_read_b64_tr_b16 v[38:39], v14 offset:2560
    v_mfma_f32_32x32x16_bf16 v[64:79], v[56:59], v[232:235], v[64:79]
    s_add_u32 m0, s61, 147456
    s_add_u32 s63, s63, 1
    buffer_load_dwordx4 v18, s[24:27], s59 offen lds
    s_add_u32 s59, s59, 172032
    s_cmp_eq_u32 s63, 7
    s_cselect_b32 s59, s47, s59
    ds_read_b128 v[248:251], v12
    ds_read_b64_tr_b16 v[40:41], v14 offset:4096
    ds_read_b64_tr_b16 v[42:43], v14 offset:4608
    v_mfma_f32_32x32x16_bf16 v[64:79], v[60:63], v[236:239], v[64:79]
    ds_read_b128 v[252:255], v13
    ds_read_b64_tr_b16 v[44:45], v14 offset:6144
    ds_read_b64_tr_b16 v[46:47], v14 offset:6656
    s_waitcnt lgkmcnt(0)
    v_mfma_f32_32x32x16_bf16 v[64:79], v[32:35], v[240:243], v[64:79]
    v_mfma_f32_32x32x16_bf16 v[64:79], v[36:39], v[244:247], v[64:79]
    v_mfma_f32_32x32x16_bf16 v[64:79], v[40:43], v[248:251], v[64:79]
    v_mfma_f32_32x32x16_bf16 v[64:79], v[44:47], v[252:255], v[64:79]
    v_cmp_gt_u32 vcc, 32, v1
    s_nop 1
    v_cndmask_b32 v102, 0, v102, vcc
    v_cndmask_b32 v103, 0, v103, vcc
    v_cndmask_b32 v110, 0, v110, vcc
    v_cndmask_b32 v111, 0, v111, vcc
    s_nop 4
    v_cvt_pk_bf16_f32 v112, v64, v65
    v_cvt_pk_bf16_f32 v113, v66, v67
    v_cvt_pk_bf16_f32 v114, v68, v69
    v_cvt_pk_bf16_f32 v115, v70, v71
    v_cvt_pk_bf16_f32 v116, v72, v73
    v_cvt_pk_bf16_f32 v117, v74, v75
    v_cvt_pk_bf16_f32 v118, v76, v77
    v_cvt_pk_bf16_f32 v119, v78, v79
    v_mfma_f32_32x32x16_bf16 v[64:79], v[96:99], v[112:115], 0
    s_nop 0
    v_mfma_f32_32x32x16_bf16 v[64:79], v[100:103], v[116:119], v[64:79]
    s_nop 11
    v_permlane32_swap_b32 v76, v78
    v_permlane32_swap_b32 v77, v79
    v_max3_f32 v24, v64, v65, v66
    v_min3_f32 v25, v64, v65, v66
    v_max3_f32 v24, v24, v67, v68
    v_min3_f32 v25, v25, v67, v68
    v_max3_f32 v24, v24, v69, v70
    v_min3_f32 v25, v25, v69, v70
    v_max3_f32 v24, v24, v71, v72
    v_min3_f32 v25, v25, v71, v72
    v_max3_f32 v24, v24, v73, v74
    v_min3_f32 v25, v25, v73, v74
    v_max3_f32 v24, v24, v75, v76
    v_min3_f32 v25, v25, v75, v76
    v_max_f32 v24, v24, v77
    v_min_f32 v25, v25, v77
    v_mul_f32 v24, s68, v24
    v_mul_f32 v25, 0xbfb8aa3b, v25
    s_nop 1
    v_permlane32_swap_b32 v24, v25
    v_max_f32 v26, v24, v25
    v_max_f32 v27, v24, v25
    s_nop 1
    v_permlane32_swap_b32 v26, v27
    v_pk_fma_f32 v[120:121], v[64:65], s[68:69], v[26:27] op_sel:[0,0,1] op_sel_hi:[1,0,1] neg_lo:[0,1,1] neg_hi:[0,1,1]
    v_pk_fma_f32 v[64:65], v[64:65], s[68:69], v[26:27] op_sel_hi:[1,0,0] neg_lo:[0,0,1] neg_hi:[0,0,1]
    v_pk_fma_f32 v[122:123], v[66:67], s[68:69], v[26:27] op_sel:[0,0,1] op_sel_hi:[1,0,1] neg_lo:[0,1,1] neg_hi:[0,1,1]
    v_pk_fma_f32 v[66:67], v[66:67], s[68:69], v[26:27] op_sel_hi:[1,0,0] neg_lo:[0,0,1] neg_hi:[0,0,1]
    v_pk_fma_f32 v[124:125], v[68:69], s[68:69], v[26:27] op_sel:[0,0,1] op_sel_hi:[1,0,1] neg_lo:[0,1,1] neg_hi:[0,1,1]
    v_pk_fma_f32 v[68:69], v[68:69], s[68:69], v[26:27] op_sel_hi:[1,0,0] neg_lo:[0,0,1] neg_hi:[0,0,1]
    v_pk_fma_f32 v[126:127], v[70:71], s[68:69], v[26:27] op_sel:[0,0,1] op_sel_hi:[1,0,1] neg_lo:[0,1,1] neg_hi:[0,1,1]
    v_pk_fma_f32 v[70:71], v[70:71], s[68:69], v[26:27] op_sel_hi:[1,0,0] neg_lo:[0,0,1] neg_hi:[0,0,1]
    v_pk_fma_f32 v[128:129], v[72:73], s[68:69], v[26:27] op_sel:[0,0,1] op_sel_hi:[1,0,1] neg_lo:[0,1,1] neg_hi:[0,1,1]
    v_pk_fma_f32 v[72:73], v[72:73], s[68:69], v[26:27] op_sel_hi:[1,0,0] neg_lo:[0,0,1] neg_hi:[0,0,1]
    v_pk_fma_f32 v[130:131], v[74:75], s[68:69], v[26:27] op_sel:[0,0,1] op_sel_hi:[1,0,1] neg_lo:[0,1,1] neg_hi:[0,1,1]
    v_pk_fma_f32 v[74:75], v[74:75], s[68:69], v[26:27] op_sel_hi:[1,0,0] neg_lo:[0,0,1] neg_hi:[0,0,1]
    v_pk_fma_f32 v[132:133], v[76:77], s[68:69], v[26:27] op_sel:[0,0,1] op_sel_hi:[1,0,1] neg_lo:[0,1,1] neg_hi:[0,1,1]
    v_pk_fma_f32 v[76:77], v[76:77], s[68:69], v[26:27] op_sel_hi:[1,0,0] neg_lo:[0,0,1] neg_hi:[0,0,1]
    s_waitcnt vmcnt(4)
    s_barrier
    ds_read_b64_tr_b16 v[48:49], v15 offset:0
    ds_read_b64_tr_b16 v[50:51], v15 offset:512
    ds_read_b64_tr_b16 v[52:53], v15 offset:2048
    ds_read_b64_tr_b16 v[54:55], v15 offset:2560
    ds_read_b64_tr_b16 v[56:57], v15 offset:4096
    ds_read_b64_tr_b16 v[58:59], v15 offset:4608
    ds_read_b64_tr_b16 v[60:61], v15 offset:6144
    ds_read_b64_tr_b16 v[62:63], v15 offset:6656
    ds_read_b64_tr_b16 v[32:33], v15 offset:8192
    ds_read_b64_tr_b16 v[34:35], v15 offset:8704
    ds_read_b64_tr_b16 v[36:37], v15 offset:10240
    ds_read_b64_tr_b16 v[38:39], v15 offset:10752
    ds_read_b64_tr_b16 v[40:41], v15 offset:12288
    ds_read_b64_tr_b16 v[42:43], v15 offset:12800
    ds_read_b64_tr_b16 v[44:45], v15 offset:14336
    ds_read_b64_tr_b16 v[46:47], v15 offset:14848
    s_waitcnt lgkmcnt(8)
    v_mfma_f32_32x32x16_bf16 v[80:95], v[48:51], v[144:147], 0
    ds_read_b64_tr_b16 v[48:49], v15 offset:16384
    ds_read_b64_tr_b16 v[50:51], v15 offset:16896
    v_exp_f32 v64, v64
    v_exp_f32 v120, v120
    v_exp_f32 v65, v65
    v_mfma_f32_32x32x16_bf16 v[80:95], v[52:55], v[148:151], v[80:95]
    ds_read_b64_tr_b16 v[52:53], v15 offset:18432
    ds_read_b64_tr_b16 v[54:55], v15 offset:18944
    v_exp_f32 v121, v121
    v_exp_f32 v66, v66
    v_exp_f32 v122, v122
    v_mfma_f32_32x32x16_bf16 v[80:95], v[56:59], v[152:155], v[80:95]
    ds_read_b64_tr_b16 v[56:57], v15 offset:20480
    ds_read_b64_tr_b16 v[58:59], v15 offset:20992
    v_exp_f32 v67, v67
    v_exp_f32 v123, v123
    v_exp_f32 v68, v68
    v_mfma_f32_32x32x16_bf16 v[80:95], v[60:63], v[156:159], v[80:95]
    ds_read_b64_tr_b16 v[60:61], v15 offset:22528
    ds_read_b64_tr_b16 v[62:63], v15 offset:23040
    v_exp_f32 v124, v124
    v_exp_f32 v69, v69
    s_waitcnt lgkmcnt(8)
    v_mfma_f32_32x32x16_bf16 v[80:95], v[32:35], v[160:163], v[80:95]
    s_waitcnt vmcnt(0)
    s_barrier
    ds_read_b64_tr_b16 v[32:33], v15 offset:24576
    ds_read_b64_tr_b16 v[34:35], v15 offset:25088
    v_exp_f32 v125, v125
    v_exp_f32 v70, v70
    v_exp_f32 v126, v126
    v_mfma_f32_32x32x16_bf16 v[80:95], v[36:39], v[164:167], v[80:95]
    ds_read_b64_tr_b16 v[36:37], v15 offset:26624
    ds_read_b64_tr_b16 v[38:39], v15 offset:27136
    v_exp_f32 v71, v71
    v_exp_f32 v127, v127
    v_exp_f32 v72, v72
    v_mfma_f32_32x32x16_bf16 v[80:95], v[40:43], v[168:171], v[80:95]
    ds_read_b64_tr_b16 v[40:41], v15 offset:28672
    ds_read_b64_tr_b16 v[42:43], v15 offset:29184
    v_exp_f32 v128, v128
    v_exp_f32 v73, v73
    v_mfma_f32_32x32x16_bf16 v[80:95], v[44:47], v[172:175], v[80:95]
    ds_read_b64_tr_b16 v[44:45], v15 offset:30720
    ds_read_b64_tr_b16 v[46:47], v15 offset:31232
    v_exp_f32 v129, v129
    v_exp_f32 v74, v74
    v_exp_f32 v130, v130
    s_waitcnt lgkmcnt(8)
    v_mfma_f32_32x32x16_bf16 v[80:95], v[48:51], v[176:179], v[80:95]
    ds_read_b64_tr_b16 v[48:49], v15 offset:32768
    ds_read_b64_tr_b16 v[50:51], v15 offset:33280
    v_exp_f32 v75, v75
    v_exp_f32 v131, v131
    v_exp_f32 v76, v76
    v_mfma_f32_32x32x16_bf16 v[80:95], v[52:55], v[180:183], v[80:95]
    ds_read_b64_tr_b16 v[52:53], v15 offset:34816
    ds_read_b64_tr_b16 v[54:55], v15 offset:35328
    v_exp_f32 v132, v132
    v_exp_f32 v77, v77
    v_exp_f32 v133, v133
    v_mfma_f32_32x32x16_bf16 v[80:95], v[56:59], v[184:187], v[80:95]
    ds_read_b64_tr_b16 v[56:57], v15 offset:36864
    ds_read_b64_tr_b16 v[58:59], v15 offset:37376
    v_add_f32 v24, v64, v65
    v_add_f32 v25, v120, v121
    v_add_f32 v24, v24, v66
    v_add_f32 v25, v25, v122
    v_mfma_f32_32x32x16_bf16 v[80:95], v[60:63], v[188:191], v[80:95]
    ds_read_b64_tr_b16 v[60:61], v15 offset:38912
    ds_read_b64_tr_b16 v[62:63], v15 offset:39424
    v_add_f32 v24, v24, v67
    v_add_f32 v25, v25, v123
    v_add_f32 v24, v24, v68
    v_add_f32 v25, v25, v124
    v_add_f32 v24, v24, v69
    s_waitcnt lgkmcnt(8)
    v_mfma_f32_32x32x16_bf16 v[80:95], v[32:35], v[192:195], v[80:95]
    ds_read_b64_tr_b16 v[32:33], v15 offset:40960
    ds_read_b64_tr_b16 v[34:35], v15 offset:41472
    v_add_f32 v25, v25, v125
    v_add_f32 v24, v24, v70
    v_add_f32 v25, v25, v126
    v_add_f32 v24, v24, v71
    v_add_f32 v25, v25, v127
    v_add_f32 v24, v24, v72
    v_mfma_f32_32x32x16_bf16 v[80:95], v[36:39], v[196:199], v[80:95]
    ds_read_b64_tr_b16 v[36:37], v15 offset:43008
    ds_read_b64_tr_b16 v[38:39], v15 offset:43520
    s_cmp_eq_u32 s48, 0
    s_cbranch_scc0 K1_NF
    buffer_load_dword v21, off, s[36:39], 0 sc1
K1_NF:
    v_add_f32 v25, v25, v128
    v_add_f32 v24, v24, v73
    v_add_f32 v25, v25, v129
    v_add_f32 v24, v24, v74
    v_add_f32 v25, v25, v130
    v_mfma_f32_32x32x16_bf16 v[80:95], v[40:43], v[200:203], v[80:95]
    ds_read_b64_tr_b16 v[40:41], v15 offset:45056
    ds_read_b64_tr_b16 v[42:43], v15 offset:45568
    v_add_f32 v24, v24, v75
    v_add_f32 v25, v25, v131
    v_add_f32 v24, v24, v76
    v_add_f32 v25, v25, v132
    v_add_f32 v24, v24, v77
    v_add_f32 v25, v25, v133
    v_mfma_f32_32x32x16_bf16 v[80:95], v[44:47], v[204:207], v[80:95]
    ds_read_b64_tr_b16 v[44:45], v15 offset:47104
    ds_read_b64_tr_b16 v[46:47], v15 offset:47616
    v_permlane32_swap_b32 v24, v25
    v_add_f32 v26, v24, v25
    v_rcp_f32 v26, v26
    s_nop 0
    v_mov_b32 v27, v26
    s_waitcnt lgkmcnt(8)
    v_mfma_f32_32x32x16_bf16 v[80:95], v[48:51], v[208:211], v[80:95]
    ds_read_b64_tr_b16 v[48:49], v15 offset:49152
    ds_read_b64_tr_b16 v[50:51], v15 offset:49664
    v_permlane32_swap_b32 v26, v27
    v_mul_f32 v64, v26, v64
    v_mul_f32 v65, v26, v65
    v_mul_f32 v66, v26, v66
    v_mul_f32 v67, v26, v67
    v_mul_f32 v68, v26, v68
    v_mfma_f32_32x32x16_bf16 v[80:95], v[52:55], v[212:215], v[80:95]
    ds_read_b64_tr_b16 v[52:53], v15 offset:51200
    ds_read_b64_tr_b16 v[54:55], v15 offset:51712
    v_mul_f32 v69, v26, v69
    v_mul_f32 v70, v26, v70
    v_mul_f32 v71, v26, v71
    v_mul_f32 v72, v26, v72
    v_mul_f32 v73, v26, v73
    v_mfma_f32_32x32x16_bf16 v[80:95], v[56:59], v[216:219], v[80:95]
    ds_read_b64_tr_b16 v[56:57], v15 offset:53248
    ds_read_b64_tr_b16 v[58:59], v15 offset:53760
    v_mul_f32 v74, v26, v74
    v_mul_f32 v75, v26, v75
    v_mul_f32 v76, v26, v76
    v_mul_f32 v77, v26, v77
    v_cvt_pk_bf16_f32 v112, v64, v65
    v_mfma_f32_32x32x16_bf16 v[80:95], v[60:63], v[220:223], v[80:95]
    ds_read_b64_tr_b16 v[60:61], v15 offset:55296
    ds_read_b64_tr_b16 v[62:63], v15 offset:55808
    v_cvt_pk_bf16_f32 v113, v66, v67
    v_cvt_pk_bf16_f32 v114, v68, v69
    v_cvt_pk_bf16_f32 v115, v70, v71
    v_cvt_pk_bf16_f32 v116, v72, v73
    v_cvt_pk_bf16_f32 v117, v74, v75
    v_cvt_pk_bf16_f32 v118, v76, v77
    s_waitcnt lgkmcnt(8)
    v_mfma_f32_32x32x16_bf16 v[80:95], v[32:35], v[224:227], v[80:95]
    v_mul_f32 v120, v27, v120
    v_mul_f32 v121, v27, v121
    v_mul_f32 v122, v27, v122
    v_mul_f32 v123, v27, v123
    v_mul_f32 v124, v27, v124
    v_mfma_f32_32x32x16_bf16 v[80:95], v[36:39], v[228:231], v[80:95]
    v_mul_f32 v125, v27, v125
    v_mul_f32 v126, v27, v126
    v_mul_f32 v127, v27, v127
    v_mul_f32 v128, v27, v128
    v_mul_f32 v129, v27, v129
    v_mul_f32 v130, v27, v130
    v_mfma_f32_32x32x16_bf16 v[80:95], v[40:43], v[232:235], v[80:95]
    v_mul_f32 v131, v27, v131
    v_mul_f32 v132, v27, v132
    v_mul_f32 v133, v27, v133
    v_cvt_pk_bf16_f32 v119, v120, v121
    v_cvt_pk_bf16_f32 v136, v122, v123
    v_mfma_f32_32x32x16_bf16 v[80:95], v[44:47], v[236:239], v[80:95]
    v_cvt_pk_bf16_f32 v137, v124, v125
    v_cvt_pk_bf16_f32 v138, v126, v127
    v_cvt_pk_bf16_f32 v139, v128, v129
    v_cvt_pk_bf16_f32 v140, v130, v131
    v_cvt_pk_bf16_f32 v141, v132, v133
    s_waitcnt lgkmcnt(0)
    v_mfma_f32_32x32x16_bf16 v[80:95], v[48:51], v[240:243], v[80:95]
    s_cmp_eq_u32 s44, 0
    s_cbranch_scc1 K1_S1
    buffer_store_dwordx4 v[112:115], v20, s[32:35], s65 offen offset:0 sc1
    buffer_store_dwordx4 v[116:119], v20, s[32:35], s65 offen offset:1024 sc1
    buffer_store_dwordx4 v[136:139], v20, s[32:35], s65 offen offset:2048 sc1
    s_branch K1_S2
K1_S1:
    ds_write_b128 v22, v[112:115]
    ds_write_b128 v23, v[116:119]
    ds_write_b128 v22, v[136:139] offset:64
    ds_write_b64 v23, v[140:141] offset:64
K1_S2:
    v_mfma_f32_32x32x16_bf16 v[80:95], v[52:55], v[244:247], v[80:95]
    v_mfma_f32_32x32x16_bf16 v[80:95], v[56:59], v[248:251], v[80:95]
    v_mfma_f32_32x32x16_bf16 v[80:95], v[60:63], v[252:255], v[80:95]
    s_cmp_eq_u32 s44, 0
    s_cbranch_scc1 K1_KV
    s_add_u32 s65, s65, 3072
    s_nop 8
    v_cvt_pk_bf16_f32 v144, v80, v81
    v_cvt_pk_bf16_f32 v145, v82, v83
    v_cvt_pk_bf16_f32 v146, v84, v85
    v_cvt_pk_bf16_f32 v147, v86, v87
    v_cvt_pk_bf16_f32 v148, v88, v89
    v_cvt_pk_bf16_f32 v149, v90, v91
    v_cvt_pk_bf16_f32 v150, v92, v93
    v_cvt_pk_bf16_f32 v151, v94, v95
    v_mfma_f32_32x32x16_bf16 v[160:175], v[104:107], v[144:147], 0
    s_nop 0
    v_mfma_f32_32x32x16_bf16 v[160:175], v[108:111], v[148:151], v[160:175]
    s_nop 11
    v_permlane32_swap_b32 v172, v174
    v_permlane32_swap_b32 v173, v175
    v_max3_f32 v24, v160, v161, v162
    v_min3_f32 v25, v160, v161, v162
    v_max3_f32 v24, v24, v163, v164
    v_min3_f32 v25, v25, v163, v164
    v_max3_f32 v24, v24, v165, v166
    v_min3_f32 v25, v25, v165, v166
    v_max3_f32 v24, v24, v167, v168
    v_min3_f32 v25, v25, v167, v168
    v_max3_f32 v24, v24, v169, v170
    v_min3_f32 v25, v25, v169, v170
    v_max3_f32 v24, v24, v171, v172
    v_min3_f32 v25, v25, v171, v172
    v_max_f32 v24, v24, v173
    v_min_f32 v25, v25, v173
    v_mul_f32 v24, s68, v24
    v_mul_f32 v25, 0xbfb8aa3b, v25
    s_nop 1
    v_permlane32_swap_b32 v24, v25
    v_max_f32 v26, v24, v25
    v_max_f32 v27, v24, v25
    s_nop 1
    v_permlane32_swap_b32 v26, v27
    v_pk_fma_f32 v[176:177], v[160:161], s[68:69], v[26:27] op_sel:[0,0,1] op_sel_hi:[1,0,1] neg_lo:[0,1,1] neg_hi:[0,1,1]
    v_pk_fma_f32 v[160:161], v[160:161], s[68:69], v[26:27] op_sel_hi:[1,0,0] neg_lo:[0,0,1] neg_hi:[0,0,1]
    v_pk_fma_f32 v[178:179], v[162:163], s[68:69], v[26:27] op_sel:[0,0,1] op_sel_hi:[1,0,1] neg_lo:[0,1,1] neg_hi:[0,1,1]
    v_pk_fma_f32 v[162:163], v[162:163], s[68:69], v[26:27] op_sel_hi:[1,0,0] neg_lo:[0,0,1] neg_hi:[0,0,1]
    v_pk_fma_f32 v[180:181], v[164:165], s[68:69], v[26:27] op_sel:[0,0,1] op_sel_hi:[1,0,1] neg_lo:[0,1,1] neg_hi:[0,1,1]
    v_pk_fma_f32 v[164:165], v[164:165], s[68:69], v[26:27] op_sel_hi:[1,0,0] neg_lo:[0,0,1] neg_hi:[0,0,1]
    v_pk_fma_f32 v[182:183], v[166:167], s[68:69], v[26:27] op_sel:[0,0,1] op_sel_hi:[1,0,1] neg_lo:[0,1,1] neg_hi:[0,1,1]
    v_pk_fma_f32 v[166:167], v[166:167], s[68:69], v[26:27] op_sel_hi:[1,0,0] neg_lo:[0,0,1] neg_hi:[0,0,1]
    v_pk_fma_f32 v[184:185], v[168:169], s[68:69], v[26:27] op_sel:[0,0,1] op_sel_hi:[1,0,1] neg_lo:[0,1,1] neg_hi:[0,1,1]
    v_pk_fma_f32 v[168:169], v[168:169], s[68:69], v[26:27] op_sel_hi:[1,0,0] neg_lo:[0,0,1] neg_hi:[0,0,1]
    v_pk_fma_f32 v[186:187], v[170:171], s[68:69], v[26:27] op_sel:[0,0,1] op_sel_hi:[1,0,1] neg_lo:[0,1,1] neg_hi:[0,1,1]
    v_pk_fma_f32 v[170:171], v[170:171], s[68:69], v[26:27] op_sel_hi:[1,0,0] neg_lo:[0,0,1] neg_hi:[0,0,1]
    v_pk_fma_f32 v[188:189], v[172:173], s[68:69], v[26:27] op_sel:[0,0,1] op_sel_hi:[1,0,1] neg_lo:[0,1,1] neg_hi:[0,1,1]
    v_pk_fma_f32 v[172:173], v[172:173], s[68:69], v[26:27] op_sel_hi:[1,0,0] neg_lo:[0,0,1] neg_hi:[0,0,1]
    v_exp_f32 v160, v160
    v_exp_f32 v176, v176
    v_exp_f32 v161, v161
    v_exp_f32 v177, v177
    v_exp_f32 v162, v162
    v_exp_f32 v178, v178
    v_exp_f32 v163, v163
    v_exp_f32 v179, v179
    v_exp_f32 v164, v164
    v_exp_f32 v180, v180
    v_exp_f32 v165, v165
    v_exp_f32 v181, v181
    v_exp_f32 v166, v166
    v_exp_f32 v182, v182
    v_exp_f32 v167, v167
    v_exp_f32 v183, v183
    v_exp_f32 v168, v168
    v_exp_f32 v184, v184
    v_exp_f32 v169, v169
    v_exp_f32 v185, v185
    v_exp_f32 v170, v170
    v_exp_f32 v186, v186
    v_exp_f32 v171, v171
    v_exp_f32 v187, v187
    v_exp_f32 v172, v172
    v_exp_f32 v188, v188
    v_exp_f32 v173, v173
    v_exp_f32 v189, v189
    v_pk_add_f32 v[28:29], v[160:161], v[162:163]
    v_pk_add_f32 v[30:31], v[176:177], v[178:179]
    v_pk_add_f32 v[28:29], v[28:29], v[164:165]
    v_pk_add_f32 v[30:31], v[30:31], v[180:181]
    v_pk_add_f32 v[28:29], v[28:29], v[166:167]
    v_pk_add_f32 v[30:31], v[30:31], v[182:183]
    v_pk_add_f32 v[28:29], v[28:29], v[168:169]
    v_pk_add_f32 v[30:31], v[30:31], v[184:185]
    v_pk_add_f32 v[28:29], v[28:29], v[170:171]
    v_pk_add_f32 v[30:31], v[30:31], v[186:187]
    v_pk_add_f32 v[28:29], v[28:29], v[172:173]
    v_pk_add_f32 v[30:31], v[30:31], v[188:189]
    v_add_f32 v24, v28, v29
    v_add_f32 v25, v30, v31
    s_nop 1
    v_permlane32_swap_b32 v24, v25
    v_add_f32 v26, v24, v25
    v_rcp_f32 v26, v26
    s_nop 0
    v_mov_b32 v27, v26
    s_nop 1
    v_permlane32_swap_b32 v26, v27
    v_pk_mul_f32 v[160:161], v[160:161], v[26:27] op_sel_hi:[1,0]
    v_pk_mul_f32 v[162:163], v[162:163], v[26:27] op_sel_hi:[1,0]
    v_pk_mul_f32 v[164:165], v[164:165], v[26:27] op_sel_hi:[1,0]
    v_pk_mul_f32 v[166:167], v[166:167], v[26:27] op_sel_hi:[1,0]
    v_pk_mul_f32 v[168:169], v[168:169], v[26:27] op_sel_hi:[1,0]
    v_pk_mul_f32 v[170:171], v[170:171], v[26:27] op_sel_hi:[1,0]
    v_pk_mul_f32 v[172:173], v[172:173], v[26:27] op_sel_hi:[1,0]
    v_cvt_pk_bf16_f32 v192, v160, v161
    v_cvt_pk_bf16_f32 v193, v162, v163
    v_cvt_pk_bf16_f32 v194, v164, v165
    v_cvt_pk_bf16_f32 v195, v166, v167
    v_cvt_pk_bf16_f32 v196, v168, v169
    v_cvt_pk_bf16_f32 v197, v170, v171
    v_cvt_pk_bf16_f32 v198, v172, v173
    v_pk_mul_f32 v[176:177], v[176:177], v[26:27] op_sel:[0,1] op_sel_hi:[1,1]
    v_pk_mul_f32 v[178:179], v[178:179], v[26:27] op_sel:[0,1] op_sel_hi:[1,1]
    v_pk_mul_f32 v[180:181], v[180:181], v[26:27] op_sel:[0,1] op_sel_hi:[1,1]
    v_pk_mul_f32 v[182:183], v[182:183], v[26:27] op_sel:[0,1] op_sel_hi:[1,1]
    v_pk_mul_f32 v[184:185], v[184:185], v[26:27] op_sel:[0,1] op_sel_hi:[1,1]
    v_pk_mul_f32 v[186:187], v[186:187], v[26:27] op_sel:[0,1] op_sel_hi:[1,1]
    v_pk_mul_f32 v[188:189], v[188:189], v[26:27] op_sel:[0,1] op_sel_hi:[1,1]
    v_cvt_pk_bf16_f32 v199, v176, v177
    v_cvt_pk_bf16_f32 v200, v178, v179
    v_cvt_pk_bf16_f32 v201, v180, v181
    v_cvt_pk_bf16_f32 v202, v182, v183
    v_cvt_pk_bf16_f32 v203, v184, v185
    v_cvt_pk_bf16_f32 v142, v186, v187
    v_cvt_pk_bf16_f32 v143, v188, v189
    buffer_store_dwordx4 v[192:195], v20, s[32:35], s65 offen offset:0 sc1
    buffer_store_dwordx4 v[196:199], v20, s[32:35], s65 offen offset:1024 sc1
    buffer_store_dwordx4 v[200:203], v20, s[32:35], s65 offen offset:2048 sc1
    buffer_store_dwordx4 v[140:143], v20, s[32:35], s65 offen offset:3072 sc1
    s_endpgm
K1_KV:
    s_nop 7
    s_nop 1
    v_cvt_pk_bf16_f32 v144, v80, v81
    v_cvt_pk_bf16_f32 v145, v82, v83
    v_cvt_pk_bf16_f32 v146, v84, v85
    v_cvt_pk_bf16_f32 v147, v86, v87
    v_cvt_pk_bf16_f32 v148, v88, v89
    v_cvt_pk_bf16_f32 v149, v90, v91
    v_cvt_pk_bf16_f32 v150, v92, v93
    v_cvt_pk_bf16_f32 v151, v94, v95
    v_cndmask_b32 v150, v2, v150, vcc
    v_cndmask_b32 v151, v2, v151, vcc
    ds_write_b128 v22, v[144:147] offset:128
    s_nop 0
    v_permlane32_swap_b32 v150, v151
    ds_write_b128 v23, v[148:151] offset:128
    s_mov_b32 s70, 0
    s_lshl_b32 s64, s66, 2
    s_add_u32 s64, s64, 163832
    v_mov_b32 v24, s64
    v_mov_b32 v25, 1
    s_mov_b64 exec, 1
    s_waitcnt lgkmcnt(0)
    ds_add_u32 v24, v25
    s_mov_b64 exec, -1
    s_bitcmp1_b32 s40, 1
    s_cbranch_scc1 K1_END
K1_SUB:
    ds_read_b32 v25, v24
    s_waitcnt lgkmcnt(0)
    v_readfirstlane_b32 s64, v25
    s_nop 0
    s_cmp_lt_u32 s64, 4
    s_cbranch_scc1 K1_SUB
    ds_read_b64_tr_b16 v[160:161], v6 offset:0
    ds_read_b64_tr_b16 v[162:163], v7 offset:768
    ds_read_b64_tr_b16 v[192:193], v4 offset:128
    ds_read_b64_tr_b16 v[194:195], v5 offset:896
    ds_read_b64_tr_b16 v[164:165], v6 offset:3072
    ds_read_b64_tr_b16 v[166:167], v7 offset:3840
    ds_read_b64_tr_b16 v[196:197], v4 offset:3200
    ds_read_b64_tr_b16 v[198:199], v5 offset:3968
    ds_read_b64_tr_b16 v[168:169], v6 offset:6144
    ds_read_b64_tr_b16 v[170:171], v7 offset:6912
    ds_read_b64_tr_b16 v[200:201], v4 offset:6272
    ds_read_b64_tr_b16 v[202:203], v5 offset:7040
    s_waitcnt lgkmcnt(8)
    v_mfma_f32_32x32x16_bf16 v[224:239], v[160:163], v[192:195], 0
    ds_read_b64_tr_b16 v[172:173], v6 offset:9216
    ds_read_b64_tr_b16 v[174:175], v7 offset:9984
    ds_read_b64_tr_b16 v[204:205], v4 offset:9344
    ds_read_b64_tr_b16 v[206:207], v5 offset:10112
    s_waitcnt lgkmcnt(8)
    v_mfma_f32_32x32x16_bf16 v[224:239], v[164:167], v[196:199], v[224:239]
    ds_read_b64_tr_b16 v[176:177], v6 offset:12288
    ds_read_b64_tr_b16 v[178:179], v7 offset:13056
    ds_read_b64_tr_b16 v[208:209], v4 offset:12416
    ds_read_b64_tr_b16 v[210:211], v5 offset:13184
    s_waitcnt lgkmcnt(8)
    v_mfma_f32_32x32x16_bf16 v[224:239], v[168:171], v[200:203], v[224:239]
    ds_read_b64_tr_b16 v[180:181], v6 offset:15360
    ds_read_b64_tr_b16 v[182:183], v7 offset:16128
    ds_read_b64_tr_b16 v[212:213], v4 offset:15488
    ds_read_b64_tr_b16 v[214:215], v5 offset:16256
    s_waitcnt lgkmcnt(8)
    v_mfma_f32_32x32x16_bf16 v[224:239], v[172:175], v[204:207], v[224:239]
    ds_read_b64_tr_b16 v[184:185], v6 offset:18432
    ds_read_b64_tr_b16 v[186:187], v7 offset:19200
    ds_read_b64_tr_b16 v[216:217], v4 offset:18560
    ds_read_b64_tr_b16 v[218:219], v5 offset:19328
    s_waitcnt lgkmcnt(8)
    v_mfma_f32_32x32x16_bf16 v[224:239], v[176:179], v[208:211], v[224:239]
    ds_read_b64_tr_b16 v[188:189], v6 offset:21504
    ds_read_b64_tr_b16 v[190:191], v7 offset:22272
    ds_read_b64_tr_b16 v[220:221], v4 offset:21632
    ds_read_b64_tr_b16 v[222:223], v5 offset:22400
    s_waitcnt lgkmcnt(8)
    v_mfma_f32_32x32x16_bf16 v[224:239], v[180:183], v[212:215], v[224:239]
    s_waitcnt lgkmcnt(4)
    v_mfma_f32_32x32x16_bf16 v[224:239], v[184:187], v[216:219], v[224:239]
    s_waitcnt lgkmcnt(0)
    v_mfma_f32_32x32x16_bf16 v[224:239], v[188:191], v[220:223], v[224:239]
    s_waitcnt vmcnt(0)
    v_readfirstlane_b32 s69, v21
K1_POLL:
    s_nop 0
    s_cmp_ge_u32 s69, 64
    s_cbranch_scc1 K1_GO
    s_add_u32 s70, s70, 1
    s_cmp_ge_u32 s70, 0x40000
    s_cbranch_scc1 K1_GO
    s_sleep 2
    buffer_load_dword v21, off, s[36:39], 0 sc1
    s_waitcnt vmcnt(0)
    v_readfirstlane_b32 s69, v21
    s_branch K1_POLL
K1_GO:
    s_nop 6
    v_cvt_pk_bf16_f32 v160, v224, v225
    buffer_atomic_pk_add_bf16 v160, v3, s[32:35], s71 offen offset:0
    v_cvt_pk_bf16_f32 v161, v226, v227
    buffer_atomic_pk_add_bf16 v161, v3, s[32:35], s71 offen offset:256
    v_cvt_pk_bf16_f32 v162, v228, v229
    buffer_atomic_pk_add_bf16 v162, v3, s[32:35], s71 offen offset:512
    v_cvt_pk_bf16_f32 v163, v230, v231
    buffer_atomic_pk_add_bf16 v163, v3, s[32:35], s71 offen offset:768
    v_cvt_pk_bf16_f32 v164, v232, v233
    buffer_atomic_pk_add_bf16 v164, v3, s[32:35], s71 offen offset:1024
    v_cvt_pk_bf16_f32 v165, v234, v235
    buffer_atomic_pk_add_bf16 v165, v3, s[32:35], s71 offen offset:1280
    s_cmp_eq_u32 s67, 1
    s_cbranch_scc1 K1_END
    v_cvt_pk_bf16_f32 v166, v236, v237
    buffer_atomic_pk_add_bf16 v166, v3, s[32:35], s71 offen offset:1536
    v_cvt_pk_bf16_f32 v167, v238, v239
    buffer_atomic_pk_add_bf16 v167, v3, s[32:35], s71 offen offset:1792
    s_endpgm
K1_A:
    s_lshl_b32 s43, s41, 3
    s_add_u32 s43, s43, s42
    s_sub_u32 s43, s43, 24
    v_lshlrev_b32 v3, 4, v1
    v_lshlrev_b32 v17, 7, v1
    s_cmp_eq_u32 s40, 6
    s_cbranch_scc0 K1A_H1
    s_getpc_b64 s[44:45]
K1_PC:
    s_sub_u32 s44, s44, K1_PC-k1_kernel
    s_subb_u32 s45, s45, 0
    global_load_dword v18, v17, s[44:45]
    s_add_u32 s44, s44, 8192
    s_addc_u32 s45, s45, 0
    global_load_dword v18, v17, s[44:45]
K1A_H1:
    s_lshl_b32 s44, s40, 8
    s_add_u32 s44, s44, s43
    s_mul_i32 s44, s44, 896
    s_mul_i32 s45, s40, 3840
    s_mul_i32 s47, s43, 896
    s_sub_u32 s49, s42, 24
    s_lshl_b32 s49, s49, 3
    s_add_u32 s49, s49, s40
    s_mul_i32 s50, s49, 18816
    s_lshl_b32 s46, s43, 3
    s_add_u32 s46, s46, s40
    s_mul_i32 s46, s46, 3584
    v_mul_u32_u24 v19, 37, v1
    v_lshrrev_b32 v19, 8, v19
    v_mul_u32_u24 v4, 1792, v19
    v_add_u32 v19, v4, v17
    s_add_u32 s50, s50, 1792
    s_nop 0
    s_mul_i32 s49, s49, 6272
    s_mov_b32 m0, s45
    s_mov_b32 exec_hi, 0x00ffffff
    s_waitcnt lgkmcnt(0)
    s_mov_b32 s36, s16
    s_mov_b32 s37, s17
    s_mov_b32 s38, 0x100
    s_mov_b32 s39, 0x20000
    s_cmp_eq_u32 s40, 7
    s_cbranch_scc0 K1A_H3
    s_add_u32 s32, s18, 0x400000
    s_addc_u32 s33, s19, 0
    s_mov_b32 s34, 0xe000
    s_mov_b32 s35, 0x20000
    s_mov_b32 exec_hi, 0x00ffffff
    v_mov_b64 v[12:13], 0
    v_mov_b64 v[14:15], 0
    buffer_store_dwordx4 v[12:15], v3, s[32:35], s47 offen sc1
K1A_H3:
    s_mov_b32 s24, s8
    s_mov_b32 s25, s9
    s_mov_b32 s26, 0x1c0000
    s_mov_b32 s27, 0x20000
    s_mov_b64 exec, 0x0fffffff
    buffer_load_dword v18, v17, s[24:27], s46 offen
    s_mov_b64 exec, -1
    s_mov_b32 s20, s4
    s_mov_b32 s21, s5
    s_mov_b32 s22, 0x1c0000
    s_mov_b32 s23, 0x20000
    s_mov_b32 exec_hi, -1
    v_and_b32 v8, 31, v1
    v_lshrrev_b32 v9, 5, v1
    v_mul_u32_u24 v10, 20480, v9
    v_mul_u32_u24 v16, 80, v8
    v_add_u32 v10, v16, v10
    v_lshl_add_u32 v10, v2, 3, v10
    v_add_u32 v10, 32768, v10
    v_lshrrev_b32 v4, 1, v8
    v_and_b32 v5, 1, v8
    v_cvt_f32_u32 v5, v5
    v_mul_f32 v5, 0xbe800000, v5
    v_cmp_eq_u32 vcc, 1, v8
    s_nop 1
    v_cndmask_b32 v4, v4, 16, vcc
    v_cndmask_b32 v5, v5, 0, vcc
    v_cvt_f32_u32 v4, v4
    v_mul_f32 v4, 0x3d000000, v4
    v_cvt_f32_u32 v11, v9
    v_mul_f32 v12, 4.0, v11
    v_add_f32 v11, v12, v12
    v_fma_f32 v5, v4, v11, v5
    v_fmamk_f32 v64, v4, 0x00000000, v5
    v_fmamk_f32 v65, v4, 0x3f800000, v5
    v_fmamk_f32 v66, v4, 0x40000000, v5
    v_fmamk_f32 v67, v4, 0x40400000, v5
    v_fmamk_f32 v68, v4, 0x40800000, v5
    v_fmamk_f32 v69, v4, 0x40a00000, v5
    v_fmamk_f32 v70, v4, 0x40c00000, v5
    v_fmamk_f32 v71, v4, 0x40e00000, v5
    v_fmamk_f32 v72, v4, 0x41800000, v5
    v_fmamk_f32 v73, v4, 0x41880000, v5
    v_fmamk_f32 v74, v4, 0x41900000, v5
    v_fmamk_f32 v75, v4, 0x41980000, v5
    v_fmamk_f32 v76, v4, 0x41a00000, v5
    v_fmamk_f32 v77, v4, 0x41a80000, v5
    v_fmamk_f32 v78, v4, 0x41b00000, v5
    v_fmamk_f32 v79, v4, 0x41b80000, v5
    v_cos_f32 v64, v64
    v_cos_f32 v65, v65
    v_cos_f32 v66, v66
    v_cos_f32 v67, v67
    v_cos_f32 v68, v68
    v_cos_f32 v69, v69
    v_cos_f32 v70, v70
    v_cos_f32 v71, v71
    v_cos_f32 v72, v72
    v_cos_f32 v73, v73
    v_cos_f32 v74, v74
    v_cos_f32 v75, v75
    v_cos_f32 v76, v76
    v_cos_f32 v77, v77
    v_cos_f32 v78, v78
    v_cos_f32 v79, v79
    v_cvt_pk_bf16_f32 v20, v64, v65
    v_cvt_pk_bf16_f32 v21, v66, v67
    v_cvt_pk_bf16_f32 v22, v68, v69
    v_cvt_pk_bf16_f32 v23, v70, v71
    v_cvt_pk_bf16_f32 v24, v72, v73
    v_cvt_pk_bf16_f32 v25, v74, v75
    v_cvt_pk_bf16_f32 v26, v76, v77
    v_cvt_pk_bf16_f32 v27, v78, v79
    v_bfe_u32 v4, v8, 2, 1
    v_bfe_u32 v5, v8, 3, 1
    v_lshl_add_u32 v4, v4, 1, v5
    v_bfe_u32 v5, v8, 1, 1
    v_lshl_add_u32 v4, v4, 1, v5
    v_and_b32 v5, 1, v8
    v_cvt_f32_u32 v5, v5
    v_mul_f32 v5, 0xbe800000, v5
    v_and_b32 v6, 15, v8
    v_cmp_eq_u32 vcc, 1, v6
    s_nop 1
    v_cndmask_b32 v4, v4, 8, vcc
    v_cndmask_b32 v5, v5, 0, vcc
    v_cvt_f32_u32 v4, v4
    v_mul_f32 v4, 0x3d800000, v4
    v_fma_f32 v5, v4, v12, v5
    v_fmamk_f32 v64, v4, 0x00000000, v5
    v_fmamk_f32 v65, v4, 0x3f800000, v5
    v_fmamk_f32 v66, v4, 0x40000000, v5
    v_fmamk_f32 v67, v4, 0x40400000, v5
    v_fmamk_f32 v68, v4, 0x41000000, v5
    v_fmamk_f32 v69, v4, 0x41100000, v5
    v_fmamk_f32 v70, v4, 0x41200000, v5
    v_fmamk_f32 v71, v4, 0x41300000, v5
    v_cos_f32 v64, v64
    v_cos_f32 v65, v65
    v_cos_f32 v66, v66
    v_cos_f32 v67, v67
    v_cos_f32 v68, v68
    v_cos_f32 v69, v69
    v_cos_f32 v70, v70
    v_cos_f32 v71, v71
    v_cvt_pk_bf16_f32 v28, v64, v65
    v_cvt_pk_bf16_f32 v29, v66, v67
    v_cvt_pk_bf16_f32 v30, v68, v69
    v_cvt_pk_bf16_f32 v31, v70, v71
    s_cmp_eq_u32 s40, 7
    s_cbranch_scc0 K1A_N7
    v_mov_b32 v7, 1
    s_waitcnt vmcnt(0)
    s_mov_b64 exec, 1
    buffer_atomic_add v7, off, s[36:39], 0 sc1
    s_mov_b64 exec, -1
K1A_N7:
    s_mov_b32 exec_hi, 0x00ffffff
    buffer_load_dwordx4 v3, s[20:23], s44 offen  lds
    s_add_u32 m0, s45, 960
    s_add_u32 s44, s44, 57344
    buffer_load_dwordx4 v3, s[20:23], s44 offen  lds
    s_add_u32 m0, s45, 1920
    s_add_u32 s44, s44, 57344
    buffer_load_dwordx4 v3, s[20:23], s44 offen  lds
    s_add_u32 m0, s45, 2880
    s_add_u32 s44, s44, 57344
    buffer_load_dwordx4 v3, s[20:23], s44 offen  lds
    s_mov_b32 exec_hi, -1
    s_cmp_eq_u32 s40, 0
    s_cselect_b32 s47, 8, s40
    s_sub_u32 s48, 0, s47
    v_lshrrev_b32 v4, 2, v8
    v_lshlrev_b32 v4, 5, v4
    v_and_b32 v5, 3, v8
    v_add_u32 v5, 1, v5
    v_lshrrev_b32 v5, 1, v5
    v_lshl_add_u32 v4, v5, 4, v4
    v_and_b32 v5, 1, v8
    v_cmp_eq_u32 vcc, 1, v5
    v_mov_b32 v6, s48
    s_nop 0
    v_cndmask_b32 v6, v2, v6, vcc
    v_add_u32 v4, v4, v6
    v_cvt_f32_u32 v4, v4
    v_mul_f32 v4, 0x3b124925, v4
    v_mul_f32 v5, v4, v11
    v_fmamk_f32 v64, v4, 0x00000000, v5
    v_fmamk_f32 v65, v4, 0x3f800000, v5
    v_fmamk_f32 v66, v4, 0x40000000, v5
    v_fmamk_f32 v67, v4, 0x40400000, v5
    v_fmamk_f32 v68, v4, 0x40800000, v5
    v_fmamk_f32 v69, v4, 0x40a00000, v5
    v_fmamk_f32 v70, v4, 0x40c00000, v5
    v_fmamk_f32 v71, v4, 0x40e00000, v5
    v_fmamk_f32 v72, v4, 0x41800000, v5
    v_fmamk_f32 v73, v4, 0x41880000, v5
    v_fmamk_f32 v74, v4, 0x41900000, v5
    v_fmamk_f32 v75, v4, 0x41980000, v5
    v_fmamk_f32 v76, v4, 0x41a00000, v5
    v_fmamk_f32 v77, v4, 0x41a80000, v5
    v_fmamk_f32 v78, v4, 0x41b00000, v5
    v_fmamk_f32 v79, v4, 0x41b80000, v5
    v_sin_f32 v80, v64
    v_cos_f32 v64, v64
    v_sin_f32 v81, v65
    v_cos_f32 v65, v65
    v_sin_f32 v82, v66
    v_cos_f32 v66, v66
    v_sin_f32 v83, v67
    v_cos_f32 v67, v67
    v_sin_f32 v84, v68
    v_cos_f32 v68, v68
    v_sin_f32 v85, v69
    v_cos_f32 v69, v69
    v_sin_f32 v86, v70
    v_cos_f32 v70, v70
    v_sin_f32 v87, v71
    v_cos_f32 v71, v71
    v_sin_f32 v88, v72
    v_cos_f32 v72, v72
    v_sin_f32 v89, v73
    v_cos_f32 v73, v73
    v_sin_f32 v90, v74
    v_cos_f32 v74, v74
    v_sin_f32 v91, v75
    v_cos_f32 v75, v75
    v_sin_f32 v92, v76
    v_cos_f32 v76, v76
    v_sin_f32 v93, v77
    v_cos_f32 v77, v77
    v_sin_f32 v94, v78
    v_cos_f32 v78, v78
    v_sin_f32 v95, v79
    v_cos_f32 v79, v79
    v_cvt_pk_bf16_f32 v32, v64, v65
    v_cvt_pk_bf16_f32 v40, v80, v81
    v_cvt_pk_bf16_f32 v33, v66, v67
    v_cvt_pk_bf16_f32 v41, v82, v83
    v_cvt_pk_bf16_f32 v34, v68, v69
    v_cvt_pk_bf16_f32 v42, v84, v85
    v_cvt_pk_bf16_f32 v35, v70, v71
    v_cvt_pk_bf16_f32 v43, v86, v87
    v_cvt_pk_bf16_f32 v36, v72, v73
    v_cvt_pk_bf16_f32 v44, v88, v89
    v_cvt_pk_bf16_f32 v37, v74, v75
    v_cvt_pk_bf16_f32 v45, v90, v91
    v_cvt_pk_bf16_f32 v38, v76, v77
    v_cvt_pk_bf16_f32 v46, v92, v93
    v_cvt_pk_bf16_f32 v39, v78, v79
    v_cvt_pk_bf16_f32 v47, v94, v95
    s_cmp_eq_u32 s40, 0
    s_cbranch_scc1 K1A_SPEC
    v_mov_b32 v4, 0x80008000
    v_cndmask_b32 v5, v4, 0, vcc
    v_cndmask_b32 v6, 0, v4, vcc
    v_xor_b32 v48, v5, v40
    v_xor_b32 v56, v6, v32
    v_xor_b32 v49, v5, v41
    v_xor_b32 v57, v6, v33
    v_xor_b32 v50, v5, v42
    v_xor_b32 v58, v6, v34
    v_xor_b32 v51, v5, v43
    v_xor_b32 v59, v6, v35
    v_xor_b32 v52, v5, v44
    v_xor_b32 v60, v6, v36
    v_xor_b32 v53, v5, v45
    v_xor_b32 v61, v6, v37
    v_xor_b32 v54, v5, v46
    v_xor_b32 v62, v6, v38
    v_xor_b32 v55, v5, v47
    v_xor_b32 v63, v6, v39
    s_branch K1A_ST1
K1A_SPEC:
    v_cndmask_b32 v48, 0, v32, vcc
    v_cndmask_b32 v56, 0, v40, vcc
    v_cndmask_b32 v32, v32, 0, vcc
    v_cndmask_b32 v40, v40, 0, vcc
    v_cndmask_b32 v49, 0, v33, vcc
    v_cndmask_b32 v57, 0, v41, vcc
    v_cndmask_b32 v33, v33, 0, vcc
    v_cndmask_b32 v41, v41, 0, vcc
    v_cndmask_b32 v50, 0, v34, vcc
    v_cndmask_b32 v58, 0, v42, vcc
    v_cndmask_b32 v34, v34, 0, vcc
    v_cndmask_b32 v42, v42, 0, vcc
    v_cndmask_b32 v51, 0, v35, vcc
    v_cndmask_b32 v59, 0, v43, vcc
    v_cndmask_b32 v35, v35, 0, vcc
    v_cndmask_b32 v43, v43, 0, vcc
    v_cndmask_b32 v52, 0, v36, vcc
    v_cndmask_b32 v60, 0, v44, vcc
    v_cndmask_b32 v36, v36, 0, vcc
    v_cndmask_b32 v44, v44, 0, vcc
    v_cndmask_b32 v53, 0, v37, vcc
    v_cndmask_b32 v61, 0, v45, vcc
    v_cndmask_b32 v37, v37, 0, vcc
    v_cndmask_b32 v45, v45, 0, vcc
    v_cndmask_b32 v54, 0, v38, vcc
    v_cndmask_b32 v62, 0, v46, vcc
    v_cndmask_b32 v38, v38, 0, vcc
    v_cndmask_b32 v46, v46, 0, vcc
    v_cndmask_b32 v55, 0, v39, vcc
    v_cndmask_b32 v63, 0, v47, vcc
    v_cndmask_b32 v39, v39, 0, vcc
    v_cndmask_b32 v47, v47, 0, vcc
    v_mov_b32 v4, 0xbf803f80
    v_cmp_eq_u32 vcc, 0, v8
    s_nop 1
    v_cndmask_b32 v40, v40, v4, vcc
    v_cndmask_b32 v41, v41, v4, vcc
    v_cndmask_b32 v42, v42, v4, vcc
    v_cndmask_b32 v43, v43, v4, vcc
    v_cndmask_b32 v44, v44, v4, vcc
    v_cndmask_b32 v45, v45, v4, vcc
    v_cndmask_b32 v46, v46, v4, vcc
    v_cndmask_b32 v47, v47, v4, vcc
K1A_ST1:
    s_mov_b32 s24, s10
    s_mov_b32 s25, s11
    s_mov_b32 s26, 0x126000
    s_mov_b32 s27, 0x20000
    s_mov_b32 exec_hi, 0x1ffff
    buffer_load_dword v18, v19, s[24:27], s50 offen
    s_mov_b64 exec, -1
    v_bfe_u32 v4, v1, 2, 2
    v_lshl_add_u32 v4, v9, 3, v4
    v_mul_u32_u24 v4, 960, v4
    v_and_b32 v5, 1, v1
    v_bfe_u32 v6, v1, 4, 1
    v_lshl_add_u32 v5, v5, 1, v6
    v_bfe_u32 v6, v1, 1, 1
    v_lshl_add_u32 v5, v5, 1, v6
    v_mad_u32_u24 v4, v5, 56, v4
    v_lshl_add_u32 v4, v2, 3, v4
    v_mul_u32_u24 v13, 5120, v2
    v_add_u32 v13, v16, v13
    v_lshl_add_u32 v13, v9, 4, v13
    v_add_u32 v13, 32768, v13
    v_mul_u32_u24 v14, 1032, v8
    v_lshl_add_u32 v14, v9, 7, v14
    v_add_u32 v14, 73728, v14
    s_lshl_b32 s48, s48, 1
    v_add_u32 v15, s48, v14
    v_lshl_add_u32 v14, v2, 1, v14
    v_mov_b64 v[64:65], 0
    v_mov_b64 v[66:67], 0
    v_mov_b64 v[68:69], 0
    v_mov_b64 v[70:71], 0
    v_mov_b64 v[72:73], 0
    v_mov_b64 v[74:75], 0
    v_mov_b64 v[76:77], 0
    v_mov_b64 v[78:79], 0
    s_waitcnt vmcnt(1)
    s_barrier
    s_cmp_eq_u32 s40, 7
    s_cbranch_scc1 K1A_VW
    ds_read_b64_tr_b16 v[64:65], v4 offset:0
    ds_read_b64_tr_b16 v[66:67], v4 offset:3840
    ds_read_b64_tr_b16 v[68:69], v4 offset:15360
    ds_read_b64_tr_b16 v[70:71], v4 offset:19200
    ds_read_b64_tr_b16 v[72:73], v4 offset:448
    ds_read_b64_tr_b16 v[74:75], v4 offset:4288
    ds_read_b64_tr_b16 v[76:77], v4 offset:15808
    ds_read_b64_tr_b16 v[78:79], v4 offset:19648
    s_waitcnt lgkmcnt(4)
    v_mfma_f32_32x32x16_bf16 v[96:111], v[64:67], v[20:23], 0
    v_mfma_f32_32x32x16_bf16 v[96:111], v[68:71], v[24:27], v[96:111]
    s_waitcnt lgkmcnt(0)
    v_mfma_f32_32x32x16_bf16 v[112:127], v[72:75], v[20:23], 0
    v_mfma_f32_32x32x16_bf16 v[112:127], v[76:79], v[24:27], v[112:127]
    s_nop 8
    v_cvt_pk_bf16_f32 v80, v96, v100
    v_cvt_pk_bf16_f32 v81, v104, v108
    v_cvt_pk_bf16_f32 v84, v97, v101
    v_cvt_pk_bf16_f32 v85, v105, v109
    v_cvt_pk_bf16_f32 v88, v98, v102
    v_cvt_pk_bf16_f32 v89, v106, v110
    v_cvt_pk_bf16_f32 v92, v99, v103
    v_cvt_pk_bf16_f32 v93, v107, v111
    v_cvt_pk_bf16_f32 v82, v112, v116
    v_cvt_pk_bf16_f32 v83, v120, v124
    v_cvt_pk_bf16_f32 v86, v113, v117
    v_cvt_pk_bf16_f32 v87, v121, v125
    v_cvt_pk_bf16_f32 v90, v114, v118
    v_cvt_pk_bf16_f32 v91, v122, v126
    v_cvt_pk_bf16_f32 v94, v115, v119
    v_cvt_pk_bf16_f32 v95, v123, v127
    v_mfma_f32_32x32x16_bf16 v[96:111], v[28:31], v[80:83], 0
    v_mfma_f32_32x32x16_bf16 v[112:127], v[28:31], v[84:87], 0
    v_mfma_f32_32x32x16_bf16 v[128:143], v[28:31], v[88:91], 0
    v_mfma_f32_32x32x16_bf16 v[144:159], v[28:31], v[92:95], 0
    s_nop 9
    v_cvt_pk_bf16_f32 v64, v96, v112
    v_cvt_pk_bf16_f32 v66, v97, v113
    v_cvt_pk_bf16_f32 v68, v98, v114
    v_cvt_pk_bf16_f32 v70, v99, v115
    v_cvt_pk_bf16_f32 v72, v100, v116
    v_cvt_pk_bf16_f32 v74, v101, v117
    v_cvt_pk_bf16_f32 v76, v102, v118
    v_cvt_pk_bf16_f32 v78, v103, v119
    v_cvt_pk_bf16_f32 v65, v128, v144
    v_cvt_pk_bf16_f32 v67, v129, v145
    v_cvt_pk_bf16_f32 v69, v130, v146
    v_cvt_pk_bf16_f32 v71, v131, v147
    v_cvt_pk_bf16_f32 v73, v132, v148
    v_cvt_pk_bf16_f32 v75, v133, v149
    v_cvt_pk_bf16_f32 v77, v134, v150
    v_cvt_pk_bf16_f32 v79, v135, v151
K1A_VW:
    ds_write_b64 v10, v[64:65] offset:0
    ds_write_b64 v10, v[66:67] offset:2560
    ds_write_b64 v10, v[68:69] offset:5120
    ds_write_b64 v10, v[70:71] offset:7680
    ds_write_b64 v10, v[72:73] offset:10240
    ds_write_b64 v10, v[74:75] offset:12800
    ds_write_b64 v10, v[76:77] offset:15360
    ds_write_b64 v10, v[78:79] offset:17920
    s_waitcnt lgkmcnt(0)
    s_barrier
    ds_read_b128 v[64:67], v13 offset:0
    ds_read_b128 v[68:71], v13 offset:32
    ds_read_b128 v[72:75], v13 offset:2560
    ds_read_b128 v[76:79], v13 offset:2592
    s_mov_b32 s24, s14
    s_mov_b32 s25, s15
    s_mov_b32 s26, 0x62000
    s_mov_b32 s27, 0x20000
    buffer_load_dword v18, v17, s[24:27], s49 offen
    s_cmp_ge_u32 s40, 6
    s_cbranch_scc0 K1A_E
    s_getpc_b64 s[44:45]
K1_PC2:
    s_add_u32 s44, s44, k2_kernel-K1_PC2
    s_addc_u32 s45, s45, 0
    s_sub_u32 s46, s40, 6
    s_lshl_b32 s46, s46, 13
    v_add_u32 v6, s46, v17
    v_min_u32 v6, K2_END-k2_kernel, v6
    global_load_dword v18, v6, s[44:45]
K1A_E:
    s_waitcnt lgkmcnt(3)
    v_mfma_f32_32x32x16_bf16 v[96:111], v[32:35], v[64:67], 0
    v_mfma_f32_32x32x16_bf16 v[112:127], v[40:43], v[64:67], 0
    s_waitcnt lgkmcnt(2)
    v_mfma_f32_32x32x16_bf16 v[96:111], v[36:39], v[68:71], v[96:111]
    v_mfma_f32_32x32x16_bf16 v[112:127], v[44:47], v[68:71], v[112:127]
    s_waitcnt lgkmcnt(1)
    v_mfma_f32_32x32x16_bf16 v[96:111], v[48:51], v[72:75], v[96:111]
    v_mfma_f32_32x32x16_bf16 v[112:127], v[56:59], v[72:75], v[112:127]
    s_waitcnt lgkmcnt(0)
    v_mfma_f32_32x32x16_bf16 v[96:111], v[52:55], v[76:79], v[96:111]
    v_mfma_f32_32x32x16_bf16 v[112:127], v[60:63], v[76:79], v[112:127]
    s_add_u32 s32, s18, 0x500000
    s_addc_u32 s33, s19, 0
    s_mov_b32 s34, 0x200000
    s_mov_b32 s35, 0x20000
    s_nop 6
    v_cvt_pk_bf16_f32 v80, v96, v97
    v_cvt_pk_bf16_f32 v81, v98, v99
    v_cvt_pk_bf16_f32 v82, v100, v101
    v_cvt_pk_bf16_f32 v83, v102, v103
    v_cvt_pk_bf16_f32 v84, v104, v105
    v_cvt_pk_bf16_f32 v85, v106, v107
    v_cvt_pk_bf16_f32 v86, v108, v109
    v_cvt_pk_bf16_f32 v87, v110, v111
    ds_write_b16 v14, v80 offset:0
    ds_write_b16_d16_hi v15, v80 offset:32
    ds_write_b16 v14, v81 offset:32
    ds_write_b16_d16_hi v15, v81 offset:64
    ds_write_b16 v14, v82 offset:256
    ds_write_b16_d16_hi v15, v82 offset:288
    ds_write_b16 v14, v83 offset:288
    ds_write_b16_d16_hi v15, v83 offset:320
    ds_write_b16 v14, v84 offset:512
    ds_write_b16_d16_hi v15, v84 offset:544
    ds_write_b16 v14, v85 offset:544
    ds_write_b16_d16_hi v15, v85 offset:576
    ds_write_b16 v14, v86 offset:768
    ds_write_b16_d16_hi v15, v86 offset:800
    ds_write_b16 v14, v87 offset:800
    ds_write_b16_d16_hi v15, v87 offset:832
    v_cvt_pk_bf16_f32 v88, v112, v113
    v_cvt_pk_bf16_f32 v89, v114, v115
    v_cvt_pk_bf16_f32 v90, v116, v117
    v_cvt_pk_bf16_f32 v91, v118, v119
    v_cvt_pk_bf16_f32 v92, v120, v121
    v_cvt_pk_bf16_f32 v93, v122, v123
    v_cvt_pk_bf16_f32 v94, v124, v125
    v_cvt_pk_bf16_f32 v95, v126, v127
    ds_write_b16 v14, v88 offset:64
    ds_write_b16_d16_hi v15, v88 offset:96
    ds_write_b16 v14, v89 offset:96
    ds_write_b16_d16_hi v15, v89 offset:128
    ds_write_b16 v14, v90 offset:320
    ds_write_b16_d16_hi v15, v90 offset:352
    ds_write_b16 v14, v91 offset:352
    ds_write_b16_d16_hi v15, v91 offset:384
    ds_write_b16 v14, v92 offset:576
    ds_write_b16_d16_hi v15, v92 offset:608
    ds_write_b16 v14, v93 offset:608
    ds_write_b16_d16_hi v15, v93 offset:640
    ds_write_b16 v14, v94 offset:832
    ds_write_b16_d16_hi v15, v94 offset:864
    ds_write_b16 v14, v95 offset:864
    ds_write_b16_d16_hi v15, v95 offset:896
    s_mul_i32 s45, s40, 4128
    s_add_u32 s45, s45, 73728
    v_add_u32 v4, s45, v3
    v_add_u32 v5, 2064, v4
    s_lshl_b32 s44, s40, 8
    s_add_u32 s44, s44, s43
    s_lshl_b32 s44, s44, 10
    v_lshlrev_b32 v6, 7, v1
    s_waitcnt lgkmcnt(0)
    s_barrier
    s_mov_b32 exec_hi, 0x00ffffff
    ds_read2_b64 v[64:67], v4 offset0:0 offset1:1
    ds_read2_b64 v[68:71], v4 offset0:129 offset1:130
    ds_read2_b64 v[72:75], v5 offset0:0 offset1:1
    ds_read2_b64 v[76:79], v5 offset0:129 offset1:130
    s_waitcnt lgkmcnt(3)
    buffer_store_dwordx4 v[64:67], v3, s[32:35], s44 offen sc1
    s_add_u32 s44, s44, 65536
    s_waitcnt lgkmcnt(2)
    buffer_store_dwordx4 v[68:71], v3, s[32:35], s44 offen sc1
    s_add_u32 s44, s44, 65536
    s_waitcnt lgkmcnt(1)
    buffer_store_dwordx4 v[72:75], v3, s[32:35], s44 offen sc1
    s_add_u32 s44, s44, 65536
    s_waitcnt lgkmcnt(0)
    buffer_store_dwordx4 v[76:79], v3, s[32:35], s44 offen sc1
    s_add_u32 s44, s44, 65536
K1_END:
    s_endpgm
.globl k2_kernel
.p2align 8
.type k2_kernel,@function
k2_kernel:
    s_cmp_ge_u32 s2, 256
    s_cbranch_scc1 K2_END
    s_load_dwordx4 s[8:11], s[0:1], 64
    s_load_dwordx2 s[12:13], s[0:1], 88
    v_and_b32 v1, 63, v0
    v_lshrrev_b32 v2, 6, v0
    s_and_b32 s41, s2, 7
    s_lshr_b32 s42, s2, 3
    v_readfirstlane_b32 s40, v2
    v_bfe_u32 v3, v1, 4, 1
    v_and_b32 v4, 7, v1
    v_lshlrev_b32 v5, 2, v3
    v_xor_b32 v4, v4, v5
    v_lshlrev_b32 v12, 4, v4
    v_lshrrev_b32 v13, 3, v1
    v_lshlrev_b32 v15, 4, v1
    s_cmp_ge_u32 s42, 28
    s_cbranch_scc1 K2_A
    s_lshr_b32 s44, s42, 2
    s_and_b32 s45, s40, 1
    s_bfe_u32 s46, s40, 0x10001
    s_cmp_ge_u32 s40, 4
    s_cbranch_scc0 K2_C
    v_mul_u32_u24 v3, 896, v13
    v_add_u32 v14, v3, v12
    v_lshrrev_b32 v4, 5, v1
    v_mul_u32_u24 v4, 25088, v4
    v_add_u32 v16, v14, v4
    s_and_b32 s50, s40, 3
    s_lshl_b32 s50, s50, 10
    s_mul_i32 s48, s45, 200704
    s_lshl_b32 s49, s44, 7
    s_add_u32 s48, s48, s49
    s_mul_i32 s49, s45, 28672
    s_add_u32 s49, s49, 57344
    s_mov_b32 m0, s50
    s_waitcnt lgkmcnt(0)
    s_add_u32 s20, s12, 0x400000
    s_addc_u32 s21, s13, 0
    s_mov_b32 s22, 0xe000
    s_mov_b32 s23, 0x20000
    buffer_load_dwordx4 v15, s[20:23], s50 offen lds
    s_add_u32 m0, m0, 4096
    s_add_u32 s50, s50, 4096
    buffer_load_dwordx4 v15, s[20:23], s50 offen lds
    s_add_u32 m0, m0, 4096
    s_add_u32 s50, s50, 4096
    buffer_load_dwordx4 v15, s[20:23], s50 offen lds
    s_add_u32 m0, m0, 4096
    s_add_u32 s50, s50, 4096
    buffer_load_dwordx4 v15, s[20:23], s50 offen lds
    s_add_u32 m0, m0, 4096
    s_add_u32 s50, s50, 4096
    buffer_load_dwordx4 v15, s[20:23], s50 offen lds
    s_add_u32 m0, m0, 4096
    s_add_u32 s50, s50, 4096
    buffer_load_dwordx4 v15, s[20:23], s50 offen lds
    s_add_u32 m0, m0, 4096
    s_add_u32 s50, s50, 4096
    buffer_load_dwordx4 v15, s[20:23], s50 offen lds
    s_add_u32 m0, m0, 4096
    s_add_u32 s50, s50, 4096
    buffer_load_dwordx4 v15, s[20:23], s50 offen lds
    s_add_u32 m0, m0, 4096
    s_add_u32 s50, s50, 4096
    buffer_load_dwordx4 v15, s[20:23], s50 offen lds
    s_add_u32 m0, m0, 4096
    s_add_u32 s50, s50, 4096
    buffer_load_dwordx4 v15, s[20:23], s50 offen lds
    s_add_u32 m0, m0, 4096
    s_add_u32 s50, s50, 4096
    buffer_load_dwordx4 v15, s[20:23], s50 offen lds
    s_add_u32 m0, m0, 4096
    s_add_u32 s50, s50, 4096
    buffer_load_dwordx4 v15, s[20:23], s50 offen lds
    s_add_u32 m0, m0, 4096
    s_add_u32 s50, s50, 4096
    buffer_load_dwordx4 v15, s[20:23], s50 offen lds
    s_add_u32 m0, m0, 4096
    s_add_u32 s50, s50, 4096
    buffer_load_dwordx4 v15, s[20:23], s50 offen lds
    s_add_u32 m0, m0, 4096
    s_add_u32 s50, s50, 4096
    s_add_u32 s28, s12, 0x500000
    s_addc_u32 s29, s13, 0
    s_mov_b32 s30, 0x200000
    s_mov_b32 s31, 0x20000
    s_cmp_eq_u32 s40, 7
    s_cbranch_scc0 K2_NP
    s_lshl_b32 s51, s42, 6
    v_add_u32 v3, s51, v1
    v_mul_u32_u24 v4, 9363, v3
    v_lshrrev_b32 v4, 16, v4
    v_lshlrev_b32 v3, 7, v3
    v_lshl_add_u32 v3, v4, 7, v3
    s_lshl_b32 s51, s41, 18
    buffer_load_dword v5, v3, s[28:31], s51 offen
K2_NP:
    s_mov_b32 s24, s8
    s_mov_b32 s25, s9
    s_mov_b32 s26, 0x62000
    s_mov_b32 s27, 0x20000
    s_cmp_eq_u32 s46, 0
    s_cbranch_scc0 K2_L1
    s_waitcnt vmcnt(7)
    s_barrier
    s_waitcnt vmcnt(0)
    s_barrier
    s_add_u32 m0, s49, 0
    s_add_u32 s50, s48, 0
    buffer_load_dwordx4 v14, s[24:27], s50 offen lds
    s_add_u32 m0, s49, 2048
    s_add_u32 s50, s48, 14336
    buffer_load_dwordx4 v14, s[24:27], s50 offen lds
    s_add_u32 m0, s49, 4096
    s_add_u32 s50, s48, 53760
    buffer_load_dwordx4 v14, s[24:27], s50 offen lds
    s_add_u32 m0, s49, 6144
    s_add_u32 s50, s48, 68096
    buffer_load_dwordx4 v14, s[24:27], s50 offen lds
    s_add_u32 m0, s49, 7168
    s_add_u32 s50, s48, 25088
    buffer_load_dwordx4 v14, s[24:27], s50 offen lds
    s_add_u32 m0, s49, 9216
    s_add_u32 s50, s48, 39424
    buffer_load_dwordx4 v14, s[24:27], s50 offen lds
    s_add_u32 m0, s49, 11264
    s_add_u32 s50, s48, 78848
    buffer_load_dwordx4 v14, s[24:27], s50 offen lds
    s_add_u32 m0, s49, 13312
    s_add_u32 s50, s48, 93184
    buffer_load_dwordx4 v14, s[24:27], s50 offen lds
    s_add_u32 m0, s49, 14336
    s_add_u32 s50, s48, 100352
    buffer_load_dwordx4 v14, s[24:27], s50 offen lds
    s_add_u32 m0, s49, 16384
    s_add_u32 s50, s48, 114688
    buffer_load_dwordx4 v14, s[24:27], s50 offen lds
    s_add_u32 m0, s49, 18432
    s_add_u32 s50, s48, 154112
    buffer_load_dwordx4 v14, s[24:27], s50 offen lds
    s_add_u32 m0, s49, 20480
    s_add_u32 s50, s48, 168448
    buffer_load_dwordx4 v14, s[24:27], s50 offen lds
    s_add_u32 m0, s49, 21504
    s_add_u32 s50, s48, 125440
    buffer_load_dwordx4 v14, s[24:27], s50 offen lds
    s_add_u32 m0, s49, 23552
    s_add_u32 s50, s48, 139776
    buffer_load_dwordx4 v14, s[24:27], s50 offen lds
    s_add_u32 m0, s49, 25600
    s_add_u32 s50, s48, 179200
    buffer_load_dwordx4 v14, s[24:27], s50 offen lds
    s_add_u32 m0, s49, 27648
    s_add_u32 s50, s48, 193536
    buffer_load_dwordx4 v14, s[24:27], s50 offen lds
    s_waitcnt vmcnt(12)
    s_barrier
    s_waitcnt vmcnt(8)
    s_barrier
    s_waitcnt vmcnt(4)
    s_barrier
    s_waitcnt vmcnt(0)
    s_barrier
    s_endpgm
K2_L1:
    s_waitcnt vmcnt(7)
    s_barrier
    s_waitcnt vmcnt(0)
    s_barrier
    s_add_u32 m0, s49, 1024
    s_add_u32 s50, s48, 7168
    buffer_load_dwordx4 v14, s[24:27], s50 offen lds
    s_add_u32 m0, s49, 3072
    s_add_u32 s50, s48, 21504
    buffer_load_dwordx4 v16, s[24:27], s50 offen lds
    s_add_u32 m0, s49, 5120
    s_add_u32 s50, s48, 60928
    buffer_load_dwordx4 v14, s[24:27], s50 offen lds
    s_add_u32 m0, s49, 8192
    s_add_u32 s50, s48, 32256
    buffer_load_dwordx4 v14, s[24:27], s50 offen lds
    s_add_u32 m0, s49, 10240
    s_add_u32 s50, s48, 46592
    buffer_load_dwordx4 v16, s[24:27], s50 offen lds
    s_add_u32 m0, s49, 12288
    s_add_u32 s50, s48, 86016
    buffer_load_dwordx4 v14, s[24:27], s50 offen lds
    s_add_u32 m0, s49, 15360
    s_add_u32 s50, s48, 107520
    buffer_load_dwordx4 v14, s[24:27], s50 offen lds
    s_add_u32 m0, s49, 17408
    s_add_u32 s50, s48, 121856
    buffer_load_dwordx4 v16, s[24:27], s50 offen lds
    s_add_u32 m0, s49, 19456
    s_add_u32 s50, s48, 161280
    buffer_load_dwordx4 v14, s[24:27], s50 offen lds
    s_add_u32 m0, s49, 22528
    s_add_u32 s50, s48, 132608
    buffer_load_dwordx4 v14, s[24:27], s50 offen lds
    s_add_u32 m0, s49, 24576
    s_add_u32 s50, s48, 146944
    buffer_load_dwordx4 v16, s[24:27], s50 offen lds
    s_add_u32 m0, s49, 26624
    s_add_u32 s50, s48, 186368
    buffer_load_dwordx4 v14, s[24:27], s50 offen lds
    s_waitcnt vmcnt(9)
    s_barrier
    s_waitcnt vmcnt(6)
    s_barrier
    s_waitcnt vmcnt(3)
    s_barrier
    s_waitcnt vmcnt(0)
    s_barrier
    s_endpgm
K2_C:
    s_and_b32 s43, s42, 3
    s_lshl_b32 s41, s41, 2
    s_add_u32 s43, s43, s41
    s_lshl_b32 s51, s43, 1
    s_add_u32 s51, s51, s45
    s_lshl_b32 s52, s51, 4
    s_lshl_b32 s53, s46, 3
    s_add_u32 s52, s52, s53
    s_mul_i32 s52, s52, 3584
    s_add_u32 s57, s52, 4096
    s_waitcnt lgkmcnt(0)
    s_mov_b32 s24, s12
    s_mov_b32 s25, s13
    s_mov_b32 s26, 0x380000
    s_mov_b32 s27, 0x20000
    v_mov_b32 v16, v15
    buffer_load_dwordx4 v[144:147], v16, s[24:27], s52 offen offset:0
    buffer_load_dwordx4 v[148:151], v16, s[24:27], s52 offen offset:1024
    buffer_load_dwordx4 v[152:155], v16, s[24:27], s52 offen offset:2048
    buffer_load_dwordx4 v[156:159], v16, s[24:27], s52 offen offset:3072
    buffer_load_dwordx4 v[160:163], v16, s[24:27], s57 offen offset:0
    buffer_load_dwordx4 v[164:167], v16, s[24:27], s57 offen offset:1024
    buffer_load_dwordx4 v[168:171], v16, s[24:27], s57 offen offset:2048
    s_add_u32 s52, s52, 7168
    s_add_u32 s57, s57, 7168
    s_mov_b32 s28, s10
    s_mov_b32 s29, s11
    s_mov_b32 s30, 0x380000
    s_mov_b32 s31, 0x20000
    v_and_b32 v8, 31, v1
    v_lshrrev_b32 v9, 5, v1
    v_bfe_u32 v10, v1, 2, 2
    v_bfe_u32 v3, v1, 4, 1
    v_and_b32 v4, 1, v1
    v_lshl_add_u32 v4, v3, 1, v4
    v_bfe_u32 v5, v1, 1, 1
    v_lshl_add_u32 v4, v4, 1, v5
    v_lshlrev_b32 v11, 3, v4
    s_mul_i32 s53, s46, 7168
    v_lshlrev_b32 v3, 2, v1
    v_add_u32 v17, s53, v3
    s_mul_i32 s53, s46, 28672
    s_add_u32 s53, s53, 57344
    v_lshl_add_u32 v3, v9, 2, v10
    v_lshlrev_b32 v3, 7, v3
    v_lshrrev_b32 v4, 1, v10
    v_lshl_add_u32 v3, v4, 6, v3
    v_add3_u32 v18, v3, v11, s53
    s_lshl_b32 s55, s46, 6
    v_xor_b32 v19, s55, v18
    v_xor_b32 v18, 64, v19
    v_lshlrev_b32 v3, 1, v9
    v_xor_b32 v3, v3, v10
    v_lshrrev_b32 v4, 1, v3
    v_lshlrev_b32 v3, 7, v3
    v_lshl_add_u32 v3, v4, 6, v3
    v_add3_u32 v20, v3, v11, s53
    v_xor_b32 v21, s55, v20
    v_xor_b32 v20, 64, v21
    s_lshl_b32 s53, s40, 12
    s_add_u32 s53, s53, 114688
    v_add_u32 v6, s53, v16
    s_xor_b32 s53, s53, 8192
    v_add_u32 v7, s53, v16
    s_lshl_b32 s51, s51, 5
    s_mul_i32 s53, s45, 4608
    s_lshl_b32 s55, s46, 6
    s_add_u32 s55, s55, s53
    v_mul_u32_u24 v2, 144, v8
    v_lshl_add_u32 v2, v9, 4, v2
    v_add_u32 v2, s55, v2
    s_mul_i32 s55, s46, 2304
    s_add_u32 s55, s55, s53
    v_mul_u32_u24 v3, 144, v13
    v_and_b32 v4, 7, v1
    v_lshl_add_u32 v3, v4, 4, v3
    v_add_u32 v3, s55, v3
    v_mul_u32_u24 v5, 1792, v13
    v_lshl_add_u32 v5, v4, 4, v5
    s_lshl_b32 s55, s46, 4
    s_add_u32 s51, s51, s55
    s_mul_i32 s54, s51, 1792
    s_lshl_b32 s55, s44, 7
    s_add_u32 s54, s54, s55
    s_add_u32 s54, s54, 896
    v_mov_b64 v[38:39], 0
    v_mov_b64 v[52:53], 0
    s_mov_b32 s56, 0x358637bd
    s_barrier
    ds_read2st64_b32 v[24:25], v17 offset0:0 offset1:1
    ds_read2st64_b32 v[26:27], v17 offset0:2 offset1:3
    ds_read2st64_b32 v[28:29], v17 offset0:4 offset1:5
    ds_read2st64_b32 v[30:31], v17 offset0:6 offset1:7
    ds_read2st64_b32 v[32:33], v17 offset0:8 offset1:9
    ds_read2st64_b32 v[34:35], v17 offset0:10 offset1:11
    ds_read2st64_b32 v[36:37], v17 offset0:12 offset1:13
    ds_read2st64_b32 v[40:41], v17 offset0:14 offset1:15
    ds_read2st64_b32 v[42:43], v17 offset0:16 offset1:17
    ds_read2st64_b32 v[44:45], v17 offset0:18 offset1:19
    ds_read2st64_b32 v[46:47], v17 offset0:20 offset1:21
    ds_read2st64_b32 v[48:49], v17 offset0:22 offset1:23
    ds_read2st64_b32 v[50:51], v17 offset0:24 offset1:25
    ds_read2st64_b32 v[54:55], v17 offset0:26 offset1:27
    s_waitcnt lgkmcnt(7) vmcnt(0)
    v_mfma_f32_32x32x16_bf16 v[72:87], v[24:27], v[144:147], 0
    ds_read2st64_b32 v[24:25], v17 offset0:56 offset1:57
    ds_read2st64_b32 v[26:27], v17 offset0:58 offset1:59
    buffer_load_dwordx4 v[172:175], v16, s[24:27], s52 offen offset:0
    buffer_load_dwordx4 v[176:179], v16, s[24:27], s52 offen offset:1024
    v_mfma_f32_32x32x16_bf16 v[72:87], v[28:31], v[148:151], v[72:87]
    ds_read2st64_b32 v[28:29], v17 offset0:60 offset1:61
    ds_read2st64_b32 v[30:31], v17 offset0:62 offset1:63
    buffer_load_dwordx4 v[180:183], v16, s[24:27], s52 offen offset:2048
    buffer_load_dwordx4 v[184:187], v16, s[24:27], s52 offen offset:3072
    v_mfma_f32_32x32x16_bf16 v[72:87], v[32:35], v[152:155], v[72:87]
    ds_read2st64_b32 v[32:33], v17 offset0:64 offset1:65
    ds_read2st64_b32 v[34:35], v17 offset0:66 offset1:67
    buffer_load_dwordx4 v[188:191], v16, s[24:27], s57 offen offset:0
    buffer_load_dwordx4 v[192:195], v16, s[24:27], s57 offen offset:1024
    v_mfma_f32_32x32x16_bf16 v[72:87], v[36:39], v[168:171], v[72:87]
    ds_read2st64_b32 v[36:37], v17 offset0:68 offset1:69
    buffer_load_dwordx4 v[196:199], v16, s[24:27], s57 offen offset:2048
    s_add_u32 s52, s52, 7168
    s_add_u32 s57, s57, 7168
    s_waitcnt lgkmcnt(7)
    v_mfma_f32_32x32x16_bf16 v[88:103], v[40:43], v[156:159], 0
    ds_read2st64_b32 v[40:41], v17 offset0:70 offset1:71
    ds_read2st64_b32 v[42:43], v17 offset0:72 offset1:73
    s_nop 3
    v_add_f32 v22, s56, v86
    v_rcp_f32 v22, v22
    v_mov_b32 v111, 0
    v_mul_f32 v72, v22, v72
    v_mul_f32 v73, v22, v73
    v_mul_f32 v74, v22, v74
    buffer_load_dwordx4 v[200:203], v16, s[24:27], s52 offen offset:0
    buffer_load_dwordx4 v[204:207], v16, s[24:27], s52 offen offset:1024
    v_mfma_f32_32x32x16_bf16 v[88:103], v[44:47], v[160:163], v[88:103]
    ds_read2st64_b32 v[44:45], v17 offset0:74 offset1:75
    ds_read2st64_b32 v[46:47], v17 offset0:76 offset1:77
    v_mul_f32 v75, v22, v75
    v_mul_f32 v76, v22, v76
    v_mul_f32 v77, v22, v77
    v_mul_f32 v78, v22, v78
    v_mul_f32 v79, v22, v79
    v_mul_f32 v80, v22, v80
    buffer_load_dwordx4 v[208:211], v16, s[24:27], s52 offen offset:2048
    buffer_load_dwordx4 v[212:215], v16, s[24:27], s52 offen offset:3072
    v_mfma_f32_32x32x16_bf16 v[88:103], v[48:51], v[164:167], v[88:103]
    ds_read2st64_b32 v[48:49], v17 offset0:78 offset1:79
    ds_read2st64_b32 v[50:51], v17 offset0:80 offset1:81
    v_mul_f32 v81, v22, v81
    v_mul_f32 v82, v22, v82
    v_mul_f32 v83, v22, v83
    v_mul_f32 v84, v22, v84
    v_mul_f32 v85, v22, v85
    v_cvt_pk_bf16_f32 v104, v72, v73
    buffer_load_dwordx4 v[216:219], v16, s[24:27], s57 offen offset:0
    buffer_load_dwordx4 v[220:223], v16, s[24:27], s57 offen offset:1024
    v_mfma_f32_32x32x16_bf16 v[88:103], v[52:55], v[168:171], v[88:103]
    ds_read2st64_b32 v[54:55], v17 offset0:82 offset1:83
    v_cvt_pk_bf16_f32 v105, v74, v75
    v_cvt_pk_bf16_f32 v106, v76, v77
    v_cvt_pk_bf16_f32 v107, v78, v79
    v_cvt_pk_bf16_f32 v108, v80, v81
    v_cvt_pk_bf16_f32 v109, v82, v83
    v_cvt_pk_bf16_f32 v110, v84, v85
    buffer_load_dwordx4 v[224:227], v16, s[24:27], s57 offen offset:2048
    s_add_u32 s52, s52, 7168
    s_add_u32 s57, s57, 7168
    s_waitcnt lgkmcnt(7) vmcnt(7)
    v_mfma_f32_32x32x16_bf16 v[72:87], v[24:27], v[172:175], 0
    s_barrier
    ds_read2st64_b32 v[24:25], v17 offset0:112 offset1:113
    ds_read2st64_b32 v[26:27], v17 offset0:114 offset1:115
    v_add_f32 v22, s56, v102
    v_rcp_f32 v22, v22
    v_mov_b32 v15, 0
    v_mul_f32 v88, v22, v88
    v_mul_f32 v89, v22, v89
    v_mul_f32 v90, v22, v90
    buffer_load_dwordx4 v[228:231], v16, s[24:27], s52 offen offset:0
    buffer_load_dwordx4 v[232:235], v16, s[24:27], s52 offen offset:1024
    v_mfma_f32_32x32x16_bf16 v[72:87], v[28:31], v[176:179], v[72:87]
    ds_read2st64_b32 v[28:29], v17 offset0:116 offset1:117
    ds_read2st64_b32 v[30:31], v17 offset0:118 offset1:119
    v_mul_f32 v91, v22, v91
    v_mul_f32 v92, v22, v92
    v_mul_f32 v93, v22, v93
    v_mul_f32 v94, v22, v94
    v_mul_f32 v95, v22, v95
    v_mul_f32 v96, v22, v96
    buffer_load_dwordx4 v[236:239], v16, s[24:27], s52 offen offset:2048
    buffer_load_dwordx4 v[240:243], v16, s[24:27], s52 offen offset:3072
    v_mfma_f32_32x32x16_bf16 v[72:87], v[32:35], v[180:183], v[72:87]
    ds_read2st64_b32 v[32:33], v17 offset0:120 offset1:121
    ds_read2st64_b32 v[34:35], v17 offset0:122 offset1:123
    v_mul_f32 v97, v22, v97
    v_mul_f32 v98, v22, v98
    v_mul_f32 v99, v22, v99
    v_mul_f32 v100, v22, v100
    v_mul_f32 v101, v22, v101
    v_cvt_pk_bf16_f32 v8, v88, v89
    buffer_load_dwordx4 v[244:247], v16, s[24:27], s57 offen offset:0
    buffer_load_dwordx4 v[248:251], v16, s[24:27], s57 offen offset:1024
    v_mfma_f32_32x32x16_bf16 v[72:87], v[36:39], v[196:199], v[72:87]
    ds_read2st64_b32 v[36:37], v17 offset0:124 offset1:125
    v_cvt_pk_bf16_f32 v9, v90, v91
    v_cvt_pk_bf16_f32 v10, v92, v93
    v_cvt_pk_bf16_f32 v11, v94, v95
    v_cvt_pk_bf16_f32 v12, v96, v97
    v_cvt_pk_bf16_f32 v13, v98, v99
    v_cvt_pk_bf16_f32 v14, v100, v101
    buffer_load_dwordx4 v[252:255], v16, s[24:27], s57 offen offset:2048
    s_add_u32 s52, s52, 7168
    s_add_u32 s57, s57, 7168
    s_waitcnt lgkmcnt(7)
    v_mfma_f32_32x32x16_bf16 v[88:103], v[40:43], v[184:187], 0
    ds_read2st64_b32 v[40:41], v17 offset0:126 offset1:127
    ds_read2st64_b32 v[42:43], v17 offset0:128 offset1:129
    v_add_f32 v22, s56, v86
    v_rcp_f32 v22, v22
    v_mov_b32 v151, 0
    v_mul_f32 v72, v22, v72
    v_mul_f32 v73, v22, v73
    v_mul_f32 v74, v22, v74
    v_mfma_f32_32x32x16_bf16 v[88:103], v[44:47], v[188:191], v[88:103]
    ds_read2st64_b32 v[44:45], v17 offset0:130 offset1:131
    ds_read2st64_b32 v[46:47], v17 offset0:132 offset1:133
    v_mul_f32 v75, v22, v75
    v_mul_f32 v76, v22, v76
    v_mul_f32 v77, v22, v77
    v_mul_f32 v78, v22, v78
    v_mul_f32 v79, v22, v79
    v_mul_f32 v80, v22, v80
    v_mfma_f32_32x32x16_bf16 v[88:103], v[48:51], v[192:195], v[88:103]
    ds_read2st64_b32 v[48:49], v17 offset0:134 offset1:135
    ds_read2st64_b32 v[50:51], v17 offset0:136 offset1:137
    v_mul_f32 v81, v22, v81
    v_mul_f32 v82, v22, v82
    v_mul_f32 v83, v22, v83
    v_mul_f32 v84, v22, v84
    v_mul_f32 v85, v22, v85
    v_cvt_pk_bf16_f32 v144, v72, v73
    v_mfma_f32_32x32x16_bf16 v[88:103], v[52:55], v[196:199], v[88:103]
    ds_read2st64_b32 v[54:55], v17 offset0:138 offset1:139
    v_cvt_pk_bf16_f32 v145, v74, v75
    v_cvt_pk_bf16_f32 v146, v76, v77
    v_cvt_pk_bf16_f32 v147, v78, v79
    v_cvt_pk_bf16_f32 v148, v80, v81
    v_cvt_pk_bf16_f32 v149, v82, v83
    v_cvt_pk_bf16_f32 v150, v84, v85
    s_waitcnt lgkmcnt(7) vmcnt(7)
    v_mfma_f32_32x32x16_bf16 v[72:87], v[24:27], v[200:203], 0
    ds_read2st64_b32 v[24:25], v17 offset0:168 offset1:169
    ds_read2st64_b32 v[26:27], v17 offset0:170 offset1:171
    s_nop 0
    v_add_f32 v22, s56, v102
    v_rcp_f32 v22, v22
    v_mov_b32 v159, 0
    v_mul_f32 v88, v22, v88
    v_mul_f32 v89, v22, v89
    v_mul_f32 v90, v22, v90
    v_mfma_f32_32x32x16_bf16 v[72:87], v[28:31], v[204:207], v[72:87]
    ds_read2st64_b32 v[28:29], v17 offset0:172 offset1:173
    ds_read2st64_b32 v[30:31], v17 offset0:174 offset1:175
    v_mul_f32 v91, v22, v91
    v_mul_f32 v92, v22, v92
    v_mul_f32 v93, v22, v93
    v_mul_f32 v94, v22, v94
    v_mul_f32 v95, v22, v95
    v_mul_f32 v96, v22, v96
    v_mfma_f32_32x32x16_bf16 v[72:87], v[32:35], v[208:211], v[72:87]
    ds_read2st64_b32 v[32:33], v17 offset0:176 offset1:177
    ds_read2st64_b32 v[34:35], v17 offset0:178 offset1:179
    v_mul_f32 v97, v22, v97
    v_mul_f32 v98, v22, v98
    v_mul_f32 v99, v22, v99
    v_mul_f32 v100, v22, v100
    v_mul_f32 v101, v22, v101
    v_cvt_pk_bf16_f32 v152, v88, v89
    v_mfma_f32_32x32x16_bf16 v[72:87], v[36:39], v[224:227], v[72:87]
    ds_read2st64_b32 v[36:37], v17 offset0:180 offset1:181
    v_cvt_pk_bf16_f32 v153, v90, v91
    v_cvt_pk_bf16_f32 v154, v92, v93
    v_cvt_pk_bf16_f32 v155, v94, v95
    v_cvt_pk_bf16_f32 v156, v96, v97
    v_cvt_pk_bf16_f32 v157, v98, v99
    v_cvt_pk_bf16_f32 v158, v100, v101
    s_waitcnt lgkmcnt(7)
    v_mfma_f32_32x32x16_bf16 v[88:103], v[40:43], v[212:215], 0
    ds_read2st64_b32 v[40:41], v17 offset0:182 offset1:183
    ds_read2st64_b32 v[42:43], v17 offset0:184 offset1:185
    s_nop 0
    v_add_f32 v22, s56, v86
    v_rcp_f32 v22, v22
    v_mov_b32 v167, 0
    v_mul_f32 v72, v22, v72
    v_mul_f32 v73, v22, v73
    v_mul_f32 v74, v22, v74
    v_mfma_f32_32x32x16_bf16 v[88:103], v[44:47], v[216:219], v[88:103]
    ds_read2st64_b32 v[44:45], v17 offset0:186 offset1:187
    ds_read2st64_b32 v[46:47], v17 offset0:188 offset1:189
    v_mul_f32 v75, v22, v75
    v_mul_f32 v76, v22, v76
    v_mul_f32 v77, v22, v77
    v_mul_f32 v78, v22, v78
    v_mul_f32 v79, v22, v79
    v_mul_f32 v80, v22, v80
    v_mfma_f32_32x32x16_bf16 v[88:103], v[48:51], v[220:223], v[88:103]
    ds_read2st64_b32 v[48:49], v17 offset0:190 offset1:191
    ds_read2st64_b32 v[50:51], v17 offset0:192 offset1:193
    v_mul_f32 v81, v22, v81
    v_mul_f32 v82, v22, v82
    v_mul_f32 v83, v22, v83
    v_mul_f32 v84, v22, v84
    v_mul_f32 v85, v22, v85
    v_cvt_pk_bf16_f32 v160, v72, v73
    v_mfma_f32_32x32x16_bf16 v[88:103], v[52:55], v[224:227], v[88:103]
    ds_read2st64_b32 v[54:55], v17 offset0:194 offset1:195
    v_cvt_pk_bf16_f32 v161, v74, v75
    v_cvt_pk_bf16_f32 v162, v76, v77
    v_cvt_pk_bf16_f32 v163, v78, v79
    v_cvt_pk_bf16_f32 v164, v80, v81
    v_cvt_pk_bf16_f32 v165, v82, v83
    v_cvt_pk_bf16_f32 v166, v84, v85
    s_waitcnt lgkmcnt(7) vmcnt(0)
    v_mfma_f32_32x32x16_bf16 v[72:87], v[24:27], v[228:231], 0
    s_barrier
    ds_read_b64_tr_b16 v[56:57], v18 offset:0
    ds_read_b64_tr_b16 v[58:59], v18 offset:1024
    v_add_f32 v22, s56, v102
    v_rcp_f32 v22, v22
    v_mov_b32 v179, 0
    v_mul_f32 v88, v22, v88
    v_mul_f32 v89, v22, v89
    v_mul_f32 v90, v22, v90
    v_mfma_f32_32x32x16_bf16 v[72:87], v[28:31], v[232:235], v[72:87]
    ds_read_b64_tr_b16 v[64:65], v19 offset:0
    ds_read_b64_tr_b16 v[66:67], v19 offset:1024
    v_mul_f32 v91, v22, v91
    v_mul_f32 v92, v22, v92
    v_mul_f32 v93, v22, v93
    v_mul_f32 v94, v22, v94
    v_mul_f32 v95, v22, v95
    v_mul_f32 v96, v22, v96
    v_mfma_f32_32x32x16_bf16 v[72:87], v[32:35], v[236:239], v[72:87]
    ds_read_b64_tr_b16 v[60:61], v18 offset:2048
    ds_read_b64_tr_b16 v[62:63], v20 offset:3072
    v_mul_f32 v97, v22, v97
    v_mul_f32 v98, v22, v98
    v_mul_f32 v99, v22, v99
    v_mul_f32 v100, v22, v100
    v_mul_f32 v101, v22, v101
    v_cvt_pk_bf16_f32 v172, v88, v89
    v_mfma_f32_32x32x16_bf16 v[72:87], v[36:39], v[252:255], v[72:87]
    ds_read_b64_tr_b16 v[68:69], v19 offset:2048
    ds_read_b64_tr_b16 v[70:71], v21 offset:3072
    v_cvt_pk_bf16_f32 v173, v90, v91
    v_cvt_pk_bf16_f32 v174, v92, v93
    v_cvt_pk_bf16_f32 v175, v94, v95
    v_cvt_pk_bf16_f32 v176, v96, v97
    v_cvt_pk_bf16_f32 v177, v98, v99
    v_cvt_pk_bf16_f32 v178, v100, v101
    s_waitcnt lgkmcnt(8)
    v_mfma_f32_32x32x16_bf16 v[88:103], v[40:43], v[240:243], 0
    ds_read_b64_tr_b16 v[200:201], v18 offset:3584
    ds_read_b64_tr_b16 v[202:203], v18 offset:4608
    v_add_f32 v22, s56, v86
    v_rcp_f32 v22, v22
    v_mov_b32 v187, 0
    v_mul_f32 v72, v22, v72
    v_mul_f32 v73, v22, v73
    v_mul_f32 v74, v22, v74
    v_mfma_f32_32x32x16_bf16 v[88:103], v[44:47], v[244:247], v[88:103]
    ds_read_b64_tr_b16 v[208:209], v19 offset:3584
    ds_read_b64_tr_b16 v[210:211], v19 offset:4608
    v_mul_f32 v75, v22, v75
    v_mul_f32 v76, v22, v76
    v_mul_f32 v77, v22, v77
    v_mul_f32 v78, v22, v78
    v_mul_f32 v79, v22, v79
    v_mul_f32 v80, v22, v80
    v_mfma_f32_32x32x16_bf16 v[88:103], v[48:51], v[248:251], v[88:103]
    ds_read_b64_tr_b16 v[204:205], v18 offset:5632
    ds_read_b64_tr_b16 v[206:207], v20 offset:6656
    v_mul_f32 v81, v22, v81
    v_mul_f32 v82, v22, v82
    v_mul_f32 v83, v22, v83
    v_mul_f32 v84, v22, v84
    v_mul_f32 v85, v22, v85
    v_cvt_pk_bf16_f32 v180, v72, v73
    v_mfma_f32_32x32x16_bf16 v[88:103], v[52:55], v[252:255], v[88:103]
    ds_read_b64_tr_b16 v[212:213], v19 offset:5632
    ds_read_b64_tr_b16 v[214:215], v21 offset:6656
    v_cvt_pk_bf16_f32 v181, v74, v75
    v_cvt_pk_bf16_f32 v182, v76, v77
    v_cvt_pk_bf16_f32 v183, v78, v79
    v_cvt_pk_bf16_f32 v184, v80, v81
    v_cvt_pk_bf16_f32 v185, v82, v83
    v_cvt_pk_bf16_f32 v186, v84, v85
    s_waitcnt lgkmcnt(8)
    v_mfma_f32_32x32x16_bf16 v[112:127], v[56:59], v[104:107], 0
    s_barrier
    ds_read_b64_tr_b16 v[24:25], v18 offset:7168
    ds_read_b64_tr_b16 v[26:27], v18 offset:8192
    v_add_f32 v22, s56, v102
    v_rcp_f32 v22, v22
    v_mfma_f32_32x32x16_bf16 v[128:143], v[64:67], v[104:107], 0
    ds_read_b64_tr_b16 v[32:33], v19 offset:7168
    ds_read_b64_tr_b16 v[34:35], v19 offset:8192
    v_mov_b32 v195, 0
    v_mul_f32 v88, v22, v88
    v_mfma_f32_32x32x16_bf16 v[112:127], v[60:63], v[108:111], v[112:127]
    ds_read_b64_tr_b16 v[28:29], v18 offset:9216
    ds_read_b64_tr_b16 v[30:31], v20 offset:10240
    v_mul_f32 v89, v22, v89
    v_mul_f32 v90, v22, v90
    v_mfma_f32_32x32x16_bf16 v[128:143], v[68:71], v[108:111], v[128:143]
    ds_read_b64_tr_b16 v[36:37], v19 offset:9216
    ds_read_b64_tr_b16 v[38:39], v21 offset:10240
    v_mul_f32 v91, v22, v91
    v_mul_f32 v92, v22, v92
    s_waitcnt lgkmcnt(8)
    v_mfma_f32_32x32x16_bf16 v[112:127], v[200:203], v[8:11], v[112:127]
    ds_read_b64_tr_b16 v[40:41], v18 offset:10752
    ds_read_b64_tr_b16 v[42:43], v18 offset:11776
    v_mul_f32 v93, v22, v93
    v_mul_f32 v94, v22, v94
    v_mfma_f32_32x32x16_bf16 v[128:143], v[208:211], v[8:11], v[128:143]
    ds_read_b64_tr_b16 v[48:49], v19 offset:10752
    ds_read_b64_tr_b16 v[50:51], v19 offset:11776
    v_mul_f32 v95, v22, v95
    v_mul_f32 v96, v22, v96
    v_mfma_f32_32x32x16_bf16 v[112:127], v[204:207], v[12:15], v[112:127]
    ds_read_b64_tr_b16 v[44:45], v18 offset:12800
    ds_read_b64_tr_b16 v[46:47], v20 offset:13824
    v_mul_f32 v97, v22, v97
    v_mul_f32 v98, v22, v98
    v_mfma_f32_32x32x16_bf16 v[128:143], v[212:215], v[12:15], v[128:143]
    ds_read_b64_tr_b16 v[52:53], v19 offset:12800
    ds_read_b64_tr_b16 v[54:55], v21 offset:13824
    v_mul_f32 v99, v22, v99
    v_mul_f32 v100, v22, v100
    s_waitcnt lgkmcnt(8)
    v_mfma_f32_32x32x16_bf16 v[112:127], v[24:27], v[144:147], v[112:127]
    s_barrier
    ds_read_b64_tr_b16 v[56:57], v18 offset:14336
    ds_read_b64_tr_b16 v[58:59], v18 offset:15360
    v_mul_f32 v101, v22, v101
    v_cvt_pk_bf16_f32 v188, v88, v89
    v_mfma_f32_32x32x16_bf16 v[128:143], v[32:35], v[144:147], v[128:143]
    ds_read_b64_tr_b16 v[64:65], v19 offset:14336
    ds_read_b64_tr_b16 v[66:67], v19 offset:15360
    v_cvt_pk_bf16_f32 v189, v90, v91
    v_cvt_pk_bf16_f32 v190, v92, v93
    v_mfma_f32_32x32x16_bf16 v[112:127], v[28:31], v[148:151], v[112:127]
    ds_read_b64_tr_b16 v[60:61], v18 offset:16384
    ds_read_b64_tr_b16 v[62:63], v20 offset:17408
    v_cvt_pk_bf16_f32 v191, v94, v95
    v_cvt_pk_bf16_f32 v192, v96, v97
    v_mfma_f32_32x32x16_bf16 v[128:143], v[36:39], v[148:151], v[128:143]
    ds_read_b64_tr_b16 v[68:69], v19 offset:16384
    ds_read_b64_tr_b16 v[70:71], v21 offset:17408
    v_cvt_pk_bf16_f32 v193, v98, v99
    v_cvt_pk_bf16_f32 v194, v100, v101
    s_waitcnt lgkmcnt(8)
    v_mfma_f32_32x32x16_bf16 v[112:127], v[40:43], v[152:155], v[112:127]
    ds_read_b64_tr_b16 v[200:201], v18 offset:17920
    ds_read_b64_tr_b16 v[202:203], v18 offset:18944
    v_mfma_f32_32x32x16_bf16 v[128:143], v[48:51], v[152:155], v[128:143]
    ds_read_b64_tr_b16 v[208:209], v19 offset:17920
    ds_read_b64_tr_b16 v[210:211], v19 offset:18944
    v_mfma_f32_32x32x16_bf16 v[112:127], v[44:47], v[156:159], v[112:127]
    ds_read_b64_tr_b16 v[204:205], v18 offset:19968
    ds_read_b64_tr_b16 v[206:207], v20 offset:20992
    v_mfma_f32_32x32x16_bf16 v[128:143], v[52:55], v[156:159], v[128:143]
    ds_read_b64_tr_b16 v[212:213], v19 offset:19968
    ds_read_b64_tr_b16 v[214:215], v21 offset:20992
    s_waitcnt lgkmcnt(8)
    v_mfma_f32_32x32x16_bf16 v[112:127], v[56:59], v[160:163], v[112:127]
    s_barrier
    ds_read_b64_tr_b16 v[24:25], v18 offset:21504
    ds_read_b64_tr_b16 v[26:27], v18 offset:22528
    v_mfma_f32_32x32x16_bf16 v[128:143], v[64:67], v[160:163], v[128:143]
    ds_read_b64_tr_b16 v[32:33], v19 offset:21504
    ds_read_b64_tr_b16 v[34:35], v19 offset:22528
    v_mfma_f32_32x32x16_bf16 v[112:127], v[60:63], v[164:167], v[112:127]
    ds_read_b64_tr_b16 v[28:29], v18 offset:23552
    ds_read_b64_tr_b16 v[30:31], v20 offset:24576
    v_mfma_f32_32x32x16_bf16 v[128:143], v[68:71], v[164:167], v[128:143]
    ds_read_b64_tr_b16 v[36:37], v19 offset:23552
    ds_read_b64_tr_b16 v[38:39], v21 offset:24576
    s_waitcnt lgkmcnt(8)
    v_mfma_f32_32x32x16_bf16 v[112:127], v[200:203], v[172:175], v[112:127]
    ds_read_b64_tr_b16 v[40:41], v18 offset:25088
    ds_read_b64_tr_b16 v[42:43], v18 offset:26112
    v_mfma_f32_32x32x16_bf16 v[128:143], v[208:211], v[172:175], v[128:143]
    ds_read_b64_tr_b16 v[48:49], v19 offset:25088
    ds_read_b64_tr_b16 v[50:51], v19 offset:26112
    v_mfma_f32_32x32x16_bf16 v[112:127], v[204:207], v[176:179], v[112:127]
    ds_read_b64_tr_b16 v[44:45], v18 offset:27136
    ds_read_b64_tr_b16 v[46:47], v20 offset:28160
    v_mfma_f32_32x32x16_bf16 v[128:143], v[212:215], v[176:179], v[128:143]
    ds_read_b64_tr_b16 v[52:53], v19 offset:27136
    ds_read_b64_tr_b16 v[54:55], v21 offset:28160
    s_waitcnt lgkmcnt(8)
    v_mfma_f32_32x32x16_bf16 v[112:127], v[24:27], v[180:183], v[112:127]
    v_mfma_f32_32x32x16_bf16 v[112:127], v[28:31], v[184:187], v[112:127]
    v_mfma_f32_32x32x16_bf16 v[128:143], v[32:35], v[180:183], v[128:143]
    s_waitcnt lgkmcnt(0)
    v_mfma_f32_32x32x16_bf16 v[112:127], v[40:43], v[188:191], v[112:127]
    v_mfma_f32_32x32x16_bf16 v[112:127], v[44:47], v[192:195], v[112:127]
    v_mfma_f32_32x32x16_bf16 v[128:143], v[36:39], v[184:187], v[128:143]
    v_mfma_f32_32x32x16_bf16 v[128:143], v[48:51], v[188:191], v[128:143]
    v_mfma_f32_32x32x16_bf16 v[128:143], v[52:55], v[192:195], v[128:143]
    s_nop 8
    ds_write_b128 v6, v[112:115] offset:0
    ds_write_b128 v6, v[116:119] offset:1024
    ds_write_b128 v6, v[120:123] offset:2048
    ds_write_b128 v6, v[124:127] offset:3072
    s_waitcnt lgkmcnt(0)
    s_barrier
    ds_read_b128 v[24:27], v7 offset:0
    ds_read_b128 v[28:31], v7 offset:1024
    ds_read_b128 v[32:35], v7 offset:2048
    ds_read_b128 v[36:39], v7 offset:3072
    s_waitcnt lgkmcnt(2)
    v_pk_add_f32 v[128:129], v[128:129], v[24:25]
    v_pk_add_f32 v[130:131], v[130:131], v[26:27]
    v_pk_add_f32 v[132:133], v[132:133], v[28:29]
    v_pk_add_f32 v[134:135], v[134:135], v[30:31]
    v_cvt_pk_bf16_f32 v56, v128, v129
    v_cvt_pk_bf16_f32 v57, v130, v131
    v_cvt_pk_bf16_f32 v58, v132, v133
    v_cvt_pk_bf16_f32 v59, v134, v135
    ds_write_b128 v2, v[56:59] offset:0
    s_waitcnt lgkmcnt(1)
    v_pk_add_f32 v[136:137], v[136:137], v[32:33]
    v_pk_add_f32 v[138:139], v[138:139], v[34:35]
    v_pk_add_f32 v[140:141], v[140:141], v[36:37]
    v_pk_add_f32 v[142:143], v[142:143], v[38:39]
    v_cvt_pk_bf16_f32 v60, v136, v137
    v_cvt_pk_bf16_f32 v61, v138, v139
    v_cvt_pk_bf16_f32 v62, v140, v141
    v_cvt_pk_bf16_f32 v63, v142, v143
    ds_write_b128 v2, v[60:63] offset:32
    s_waitcnt lgkmcnt(0)
    s_barrier
    ds_read_b128 v[24:27], v3
    ds_read_b128 v[28:31], v3 offset:1152
    s_add_u32 s55, s54, 14336
    s_waitcnt lgkmcnt(1)
    buffer_store_dwordx4 v[24:27], v5, s[28:31], s54 offen sc1
    s_waitcnt lgkmcnt(0)
    buffer_store_dwordx4 v[28:31], v5, s[28:31], s55 offen sc1
    s_endpgm
K2_A:
    s_lshl_b32 s43, s41, 2
    s_add_u32 s43, s43, s42
    s_sub_u32 s43, s43, 28
    s_and_b32 s44, s43, 1
    s_lshr_b32 s43, s43, 1
    s_and_b32 s45, s40, 1
    s_lshr_b32 s46, s40, 1
    v_lshl_add_u32 v14, v13, 10, v12
    s_lshl_b32 s47, s43, 17
    s_lshl_b32 s48, s40, 14
    s_add_u32 s47, s47, s48
    s_add_u32 s49, s47, 8192
    s_lshl_b32 s48, s40, 11
    s_mov_b32 m0, s48
    s_lshl_b32 s56, s44, 10
    s_add_u32 s57, s43, s56
    s_lshl_b32 s59, s44, 4
    s_lshl_b32 s54, s44, 13
    s_cmp_eq_u32 s43, 0
    s_cselect_b32 s57, s59, s57
    s_cselect_b32 s54, s54, 0
    s_cselect_b32 s55, s54, 8192
    s_sub_u32 s58, 2048, s57
    s_add_u32 s59, s57, 1024
    s_cmp_eq_u32 s43, 0
    s_cselect_b32 s58, s59, s58
    s_mov_b32 s53, 4294909952
    s_cmov_b32 s53, 57344
    v_and_b32 v8, 31, v1
    v_lshrrev_b32 v9, 5, v1
    v_bfe_u32 v10, v1, 2, 2
    v_bfe_u32 v3, v1, 4, 1
    v_and_b32 v4, 1, v1
    v_lshl_add_u32 v4, v3, 1, v4
    v_bfe_u32 v5, v1, 1, 1
    v_lshl_add_u32 v4, v4, 1, v5
    v_lshlrev_b32 v11, 3, v4
    v_lshlrev_b32 v3, 5, v8
    v_add_u32 v3, s57, v3
    v_cvt_f32_u32 v4, v3
    v_mul_f32 v4, 0x3a000000, v4
    v_cvt_f32_u32 v5, v9
    v_mul_f32 v5, 0x41000000, v5
    v_mul_f32 v5, v4, v5
    s_lshr_b32 s60, s40, 1
    v_cvt_f32_u32 v6, s60
    v_mul_f32 v6, 0x41800000, v6
    v_fma_f32 v5, v4, v6, v5
    s_and_b32 s60, s40, 1
    v_cvt_f32_u32 v6, s60
    v_fmamk_f32 v5, v6, 0xbe800000, v5
    v_fmamk_f32 v88, v4, 0x00000000, v5
    v_fmamk_f32 v89, v4, 0x3f800000, v5
    v_fmamk_f32 v90, v4, 0x40000000, v5
    v_fmamk_f32 v91, v4, 0x40400000, v5
    v_fmamk_f32 v92, v4, 0x40800000, v5
    v_fmamk_f32 v93, v4, 0x40a00000, v5
    v_fmamk_f32 v94, v4, 0x40c00000, v5
    v_fmamk_f32 v95, v4, 0x40e00000, v5
    v_cos_f32 v88, v88
    v_cos_f32 v89, v89
    v_cos_f32 v90, v90
    v_cos_f32 v91, v91
    v_cos_f32 v92, v92
    v_cos_f32 v93, v93
    v_cos_f32 v94, v94
    v_cos_f32 v95, v95
    v_cvt_pk_bf16_f32 v96, v88, v89
    v_cvt_pk_bf16_f32 v97, v90, v91
    v_cvt_pk_bf16_f32 v98, v92, v93
    v_cvt_pk_bf16_f32 v99, v94, v95
    s_lshl_b32 s60, s40, 10
    v_add_u32 v7, 114688, v15
    v_add_u32 v6, s60, v7
    ds_write_b128 v6, v[96:99]
    s_waitcnt lgkmcnt(0)
    s_add_u32 s20, s12, 0x500000
    s_addc_u32 s21, s13, 0
    s_mov_b32 s22, 0x200000
    s_mov_b32 s23, 0x20000
    buffer_load_dwordx4 v14, s[20:23], s47 offen lds
    s_add_u32 m0, m0, 1024
    s_add_u32 s47, s47, 128
    buffer_load_dwordx4 v14, s[20:23], s49 offen lds
    s_add_u32 m0, m0, 15360
    s_add_u32 s49, s49, 128
    buffer_load_dwordx4 v14, s[20:23], s47 offen lds
    s_add_u32 m0, m0, 1024
    s_add_u32 s47, s47, 128
    buffer_load_dwordx4 v14, s[20:23], s49 offen lds
    s_add_u32 m0, m0, 15360
    s_add_u32 s49, s49, 128
    buffer_load_dwordx4 v14, s[20:23], s47 offen lds
    s_add_u32 m0, m0, 1024
    s_add_u32 s47, s47, 128
    buffer_load_dwordx4 v14, s[20:23], s49 offen lds
    s_add_u32 m0, m0, 15360
    s_add_u32 s49, s49, 128
    buffer_load_dwordx4 v14, s[20:23], s47 offen lds
    s_add_u32 m0, m0, 1024
    s_add_u32 s47, s47, 128
    buffer_load_dwordx4 v14, s[20:23], s49 offen lds
    s_add_u32 m0, m0, 15360
    s_add_u32 s49, s49, 128
    buffer_load_dwordx4 v14, s[20:23], s47 offen lds
    s_add_u32 m0, m0, 1024
    s_add_u32 s47, s47, 128
    buffer_load_dwordx4 v14, s[20:23], s49 offen lds
    s_add_u32 m0, m0, 15360
    s_add_u32 s49, s49, 128
    buffer_load_dwordx4 v14, s[20:23], s47 offen lds
    s_add_u32 m0, m0, 1024
    s_add_u32 s47, s47, 128
    buffer_load_dwordx4 v14, s[20:23], s49 offen lds
    s_add_u32 m0, m0, 15360
    s_add_u32 s49, s49, 128
    buffer_load_dwordx4 v14, s[20:23], s47 offen lds
    s_add_u32 m0, m0, 1024
    s_add_u32 s47, s47, 128
    buffer_load_dwordx4 v14, s[20:23], s49 offen lds
    s_add_u32 m0, m0, 15360
    s_add_u32 s49, s49, 128
    s_mov_b32 s28, s10
    s_mov_b32 s29, s11
    s_mov_b32 s30, 0x380000
    s_mov_b32 s31, 0x20000
    v_lshl_add_u32 v3, v9, 3, v10
    v_lshlrev_b32 v3, 7, v3
    v_lshrrev_b32 v4, 1, v10
    v_lshl_add_u32 v3, v4, 6, v3
    s_lshl_b32 s60, s40, 14
    v_add3_u32 v3, v3, v11, s60
    v_add_u32 v16, s54, v3
    v_add_u32 v17, s55, v3
    v_xor_b32 v19, 64, v16
    v_xor_b32 v18, 64, v17
    v_mul_u32_u24 v22, 904, v8
    s_lshl_b32 s60, s40, 6
    v_lshl_add_u32 v3, v9, 4, s60
    v_add_u32 v20, v22, v3
    v_sub_u32 v21, v22, v3
    v_add_u32 v21, 850, v21
    v_add_u32 v12, 122880, v20
    v_add_u32 v13, 122880, v21
    s_mul_i32 s50, s57, 1792
    s_mul_i32 s58, s58, 1792
    s_lshl_b32 s56, s40, 2
    s_mul_i32 s59, s56, s53
    s_add_u32 s58, s58, s59
    s_mul_i32 s59, s56, 57344
    s_add_u32 s50, s50, s59
    s_mul_i32 s56, s56, 904
    v_add_u32 v4, s56, v15
    v_add_u32 v5, 1808, v4
    v_add_u32 v2, 122880, v4
    v_add_u32 v0, 122880, v5
    s_waitcnt lgkmcnt(0)
    s_barrier
    ds_read_b128 v[24:27], v7 offset:0
    ds_read_b128 v[40:43], v7 offset:1024
    ds_read_b128 v[28:31], v7 offset:2048
    ds_read_b128 v[44:47], v7 offset:3072
    ds_read_b128 v[32:35], v7 offset:4096
    ds_read_b128 v[48:51], v7 offset:5120
    ds_read_b128 v[36:39], v7 offset:6144
    ds_read_b128 v[52:55], v7 offset:7168
    s_waitcnt lgkmcnt(0)
    s_cmp_eq_u32 s43, 0
    s_cbranch_scc1 K2A_G1
    v_xor_b32 v56, 0x80008000, v40
    v_xor_b32 v57, 0x80008000, v41
    v_xor_b32 v58, 0x80008000, v42
    v_xor_b32 v59, 0x80008000, v43
    v_xor_b32 v60, 0x80008000, v44
    v_xor_b32 v61, 0x80008000, v45
    v_xor_b32 v62, 0x80008000, v46
    v_xor_b32 v63, 0x80008000, v47
    v_xor_b32 v64, 0x80008000, v48
    v_xor_b32 v65, 0x80008000, v49
    v_xor_b32 v66, 0x80008000, v50
    v_xor_b32 v67, 0x80008000, v51
    v_xor_b32 v68, 0x80008000, v52
    v_xor_b32 v69, 0x80008000, v53
    v_xor_b32 v70, 0x80008000, v54
    v_xor_b32 v71, 0x80008000, v55
    s_branch K2A_G2
K2A_G1:
    v_xor_b32 v56, 0x80000000, v24
    v_xor_b32 v72, 0x80000000, v40
    v_xor_b32 v57, 0x80000000, v25
    v_xor_b32 v73, 0x80000000, v41
    v_xor_b32 v58, 0x80000000, v26
    v_xor_b32 v74, 0x80000000, v42
    v_xor_b32 v59, 0x80000000, v27
    v_xor_b32 v75, 0x80000000, v43
    v_xor_b32 v60, 0x80000000, v28
    v_xor_b32 v76, 0x80000000, v44
    v_xor_b32 v61, 0x80000000, v29
    v_xor_b32 v77, 0x80000000, v45
    v_xor_b32 v62, 0x80000000, v30
    v_xor_b32 v78, 0x80000000, v46
    v_xor_b32 v63, 0x80000000, v31
    v_xor_b32 v79, 0x80000000, v47
    v_xor_b32 v64, 0x80000000, v32
    v_xor_b32 v80, 0x80000000, v48
    v_xor_b32 v65, 0x80000000, v33
    v_xor_b32 v81, 0x80000000, v49
    v_xor_b32 v66, 0x80000000, v34
    v_xor_b32 v82, 0x80000000, v50
    v_xor_b32 v67, 0x80000000, v35
    v_xor_b32 v83, 0x80000000, v51
    v_xor_b32 v68, 0x80000000, v36
    v_xor_b32 v84, 0x80000000, v52
    v_xor_b32 v69, 0x80000000, v37
    v_xor_b32 v85, 0x80000000, v53
    v_xor_b32 v70, 0x80000000, v38
    v_xor_b32 v86, 0x80000000, v54
    v_xor_b32 v71, 0x80000000, v39
    v_xor_b32 v87, 0x80000000, v55
K2A_G2:
    s_waitcnt vmcnt(0)
    s_barrier
    s_cmp_eq_u32 s40, 7
    s_cbranch_scc1 K2A_B2
    ds_read_b64_tr_b16 v[88:89], v16 offset:0
    ds_read_b64_tr_b16 v[90:91], v16 offset:512
    ds_read_b64_tr_b16 v[92:93], v17 offset:0
    ds_read_b64_tr_b16 v[94:95], v17 offset:512
    ds_read_b64_tr_b16 v[96:97], v18 offset:0
    ds_read_b64_tr_b16 v[98:99], v18 offset:512
    ds_read_b64_tr_b16 v[100:101], v19 offset:0
    ds_read_b64_tr_b16 v[102:103], v19 offset:512
    ds_read_b64_tr_b16 v[104:105], v16 offset:2048
    ds_read_b64_tr_b16 v[106:107], v16 offset:2560
    ds_read_b64_tr_b16 v[108:109], v17 offset:2048
    ds_read_b64_tr_b16 v[110:111], v17 offset:2560
    ds_read_b64_tr_b16 v[112:113], v18 offset:2048
    ds_read_b64_tr_b16 v[114:115], v18 offset:2560
    ds_read_b64_tr_b16 v[116:117], v19 offset:2048
    ds_read_b64_tr_b16 v[118:119], v19 offset:2560
    s_cmp_eq_u32 s43, 0
    s_cbranch_scc1 K2A_C1
    s_waitcnt lgkmcnt(8)
    v_mfma_f32_32x32x16_bf16 v[152:167], v[88:91], v[24:27], 0
    ds_read_b64_tr_b16 v[120:121], v16 offset:4096
    ds_read_b64_tr_b16 v[122:123], v16 offset:4608
    v_mfma_f32_32x32x16_bf16 v[184:199], v[96:99], v[24:27], 0
    ds_read_b64_tr_b16 v[128:129], v18 offset:4096
    ds_read_b64_tr_b16 v[130:131], v18 offset:4608
    v_mfma_f32_32x32x16_bf16 v[152:167], v[92:95], v[56:59], v[152:167]
    ds_read_b64_tr_b16 v[124:125], v17 offset:4096
    ds_read_b64_tr_b16 v[126:127], v17 offset:4608
    v_mfma_f32_32x32x16_bf16 v[184:199], v[100:103], v[40:43], v[184:199]
    ds_read_b64_tr_b16 v[132:133], v19 offset:4096
    ds_read_b64_tr_b16 v[134:135], v19 offset:4608
    s_waitcnt lgkmcnt(8)
    v_mfma_f32_32x32x16_bf16 v[152:167], v[104:107], v[28:31], v[152:167]
    ds_read_b64_tr_b16 v[136:137], v16 offset:6144
    ds_read_b64_tr_b16 v[138:139], v16 offset:6656
    v_mfma_f32_32x32x16_bf16 v[184:199], v[112:115], v[28:31], v[184:199]
    ds_read_b64_tr_b16 v[144:145], v18 offset:6144
    ds_read_b64_tr_b16 v[146:147], v18 offset:6656
    v_mfma_f32_32x32x16_bf16 v[152:167], v[108:111], v[60:63], v[152:167]
    ds_read_b64_tr_b16 v[140:141], v17 offset:6144
    ds_read_b64_tr_b16 v[142:143], v17 offset:6656
    v_mfma_f32_32x32x16_bf16 v[184:199], v[116:119], v[44:47], v[184:199]
    ds_read_b64_tr_b16 v[148:149], v19 offset:6144
    ds_read_b64_tr_b16 v[150:151], v19 offset:6656
    s_waitcnt lgkmcnt(8)
    v_mfma_f32_32x32x16_bf16 v[152:167], v[120:123], v[32:35], v[152:167]
    v_mfma_f32_32x32x16_bf16 v[184:199], v[128:131], v[32:35], v[184:199]
    v_mfma_f32_32x32x16_bf16 v[152:167], v[124:127], v[64:67], v[152:167]
    v_mfma_f32_32x32x16_bf16 v[184:199], v[132:135], v[48:51], v[184:199]
    s_waitcnt lgkmcnt(0)
    v_mfma_f32_32x32x16_bf16 v[152:167], v[136:139], v[36:39], v[152:167]
    v_mfma_f32_32x32x16_bf16 v[184:199], v[144:147], v[36:39], v[184:199]
    v_mfma_f32_32x32x16_bf16 v[152:167], v[140:143], v[68:71], v[152:167]
    v_mfma_f32_32x32x16_bf16 v[184:199], v[148:151], v[52:55], v[184:199]
    s_cmp_eq_u32 s40, 0
    s_cbranch_scc0 K2A_NS
    v_mfma_f32_32x32x16_bf16 v[216:231], v[100:103], v[24:27], 0
    v_mfma_f32_32x32x16_bf16 v[216:231], v[96:99], v[56:59], v[216:231]
    v_mfma_f32_32x32x16_bf16 v[216:231], v[116:119], v[28:31], v[216:231]
    v_mfma_f32_32x32x16_bf16 v[216:231], v[112:115], v[60:63], v[216:231]
    v_mfma_f32_32x32x16_bf16 v[216:231], v[132:135], v[32:35], v[216:231]
    v_mfma_f32_32x32x16_bf16 v[216:231], v[128:131], v[64:67], v[216:231]
    v_mfma_f32_32x32x16_bf16 v[216:231], v[148:151], v[36:39], v[216:231]
    v_mfma_f32_32x32x16_bf16 v[216:231], v[144:147], v[68:71], v[216:231]
    s_mov_b32 exec_hi, 0
    s_nop 0
    v_mov_b32 v184, 0
    s_nop 8
    v_cvt_pk_bf16_f32 v22, v216, v216
    s_mov_b32 exec_hi, -1
K2A_NS:
    s_nop 7
    s_nop 1
    v_pk_add_f32 v[88:89], v[152:153], v[184:185] neg_lo:[0,1] neg_hi:[0,1]
    v_pk_add_f32 v[104:105], v[152:153], v[184:185]
    v_pk_add_f32 v[90:91], v[154:155], v[186:187] neg_lo:[0,1] neg_hi:[0,1]
    v_pk_add_f32 v[106:107], v[154:155], v[186:187]
    v_pk_add_f32 v[92:93], v[156:157], v[188:189] neg_lo:[0,1] neg_hi:[0,1]
    v_pk_add_f32 v[108:109], v[156:157], v[188:189]
    v_pk_add_f32 v[94:95], v[158:159], v[190:191] neg_lo:[0,1] neg_hi:[0,1]
    v_pk_add_f32 v[110:111], v[158:159], v[190:191]
    v_pk_add_f32 v[96:97], v[160:161], v[192:193] neg_lo:[0,1] neg_hi:[0,1]
    v_pk_add_f32 v[112:113], v[160:161], v[192:193]
    v_pk_add_f32 v[98:99], v[162:163], v[194:195] neg_lo:[0,1] neg_hi:[0,1]
    v_pk_add_f32 v[114:115], v[162:163], v[194:195]
    v_pk_add_f32 v[100:101], v[164:165], v[196:197] neg_lo:[0,1] neg_hi:[0,1]
    v_pk_add_f32 v[116:117], v[164:165], v[196:197]
    v_pk_add_f32 v[102:103], v[166:167], v[198:199] neg_lo:[0,1] neg_hi:[0,1]
    v_pk_add_f32 v[118:119], v[166:167], v[198:199]
    v_cvt_pk_bf16_f32 v152, v88, v89
    v_cvt_pk_bf16_f32 v153, v90, v91
    v_cvt_pk_bf16_f32 v154, v92, v93
    v_cvt_pk_bf16_f32 v155, v94, v95
    v_cvt_pk_bf16_f32 v156, v96, v97
    v_cvt_pk_bf16_f32 v157, v98, v99
    v_cvt_pk_bf16_f32 v158, v100, v101
    v_cvt_pk_bf16_f32 v159, v102, v103
    v_cvt_pk_bf16_f32 v160, v111, v104
    v_cvt_pk_bf16_f32 v161, v110, v109
    v_cvt_pk_bf16_f32 v162, v108, v107
    v_cvt_pk_bf16_f32 v163, v106, v105
    v_cvt_pk_bf16_f32 v164, v119, v112
    v_cvt_pk_bf16_f32 v165, v118, v117
    v_cvt_pk_bf16_f32 v166, v116, v115
    v_cvt_pk_bf16_f32 v167, v114, v113
    v_cvt_pk_bf16_f32 v168, v104, v105
    v_cvt_pk_bf16_f32 v169, v106, v107
    v_cvt_pk_bf16_f32 v170, v108, v109
    v_cvt_pk_bf16_f32 v171, v110, v111
    v_cvt_pk_bf16_f32 v172, v112, v113
    v_cvt_pk_bf16_f32 v173, v114, v115
    v_cvt_pk_bf16_f32 v174, v116, v117
    v_cvt_pk_bf16_f32 v175, v118, v119
    v_cvt_pk_bf16_f32 v176, v95, v88
    v_cvt_pk_bf16_f32 v177, v94, v93
    v_cvt_pk_bf16_f32 v178, v92, v91
    v_cvt_pk_bf16_f32 v179, v90, v89
    v_cvt_pk_bf16_f32 v180, v103, v96
    v_cvt_pk_bf16_f32 v181, v102, v101
    v_cvt_pk_bf16_f32 v182, v100, v99
    v_cvt_pk_bf16_f32 v183, v98, v97
    s_branch K2A_C2
K2A_C1:
    s_waitcnt lgkmcnt(8)
    v_mfma_f32_32x32x16_bf16 v[152:167], v[88:91], v[24:27], 0
    ds_read_b64_tr_b16 v[120:121], v16 offset:4096
    ds_read_b64_tr_b16 v[122:123], v16 offset:4608
    v_mfma_f32_32x32x16_bf16 v[184:199], v[96:99], v[72:75], 0
    ds_read_b64_tr_b16 v[128:129], v18 offset:4096
    ds_read_b64_tr_b16 v[130:131], v18 offset:4608
    v_mfma_f32_32x32x16_bf16 v[168:183], v[92:95], v[56:59], 0
    ds_read_b64_tr_b16 v[124:125], v17 offset:4096
    ds_read_b64_tr_b16 v[126:127], v17 offset:4608
    v_mfma_f32_32x32x16_bf16 v[200:215], v[100:103], v[40:43], 0
    ds_read_b64_tr_b16 v[132:133], v19 offset:4096
    ds_read_b64_tr_b16 v[134:135], v19 offset:4608
    s_waitcnt lgkmcnt(8)
    v_mfma_f32_32x32x16_bf16 v[152:167], v[104:107], v[28:31], v[152:167]
    ds_read_b64_tr_b16 v[136:137], v16 offset:6144
    ds_read_b64_tr_b16 v[138:139], v16 offset:6656
    v_mfma_f32_32x32x16_bf16 v[184:199], v[112:115], v[76:79], v[184:199]
    ds_read_b64_tr_b16 v[144:145], v18 offset:6144
    ds_read_b64_tr_b16 v[146:147], v18 offset:6656
    v_mfma_f32_32x32x16_bf16 v[168:183], v[108:111], v[60:63], v[168:183]
    ds_read_b64_tr_b16 v[140:141], v17 offset:6144
    ds_read_b64_tr_b16 v[142:143], v17 offset:6656
    v_mfma_f32_32x32x16_bf16 v[200:215], v[116:119], v[44:47], v[200:215]
    ds_read_b64_tr_b16 v[148:149], v19 offset:6144
    ds_read_b64_tr_b16 v[150:151], v19 offset:6656
    s_waitcnt lgkmcnt(8)
    v_mfma_f32_32x32x16_bf16 v[152:167], v[120:123], v[32:35], v[152:167]
    v_mfma_f32_32x32x16_bf16 v[184:199], v[128:131], v[80:83], v[184:199]
    v_mfma_f32_32x32x16_bf16 v[168:183], v[124:127], v[64:67], v[168:183]
    v_mfma_f32_32x32x16_bf16 v[200:215], v[132:135], v[48:51], v[200:215]
    s_waitcnt lgkmcnt(0)
    v_mfma_f32_32x32x16_bf16 v[152:167], v[136:139], v[36:39], v[152:167]
    v_mfma_f32_32x32x16_bf16 v[184:199], v[144:147], v[84:87], v[184:199]
    v_mfma_f32_32x32x16_bf16 v[168:183], v[140:143], v[68:71], v[168:183]
    v_mfma_f32_32x32x16_bf16 v[200:215], v[148:151], v[52:55], v[200:215]
    s_cmp_eq_u32 s40, 0
    s_cbranch_scc0 K2A_NT
    v_mfma_f32_32x32x16_bf16 v[216:231], v[100:103], v[24:27], 0
    v_mfma_f32_32x32x16_bf16 v[232:247], v[96:99], v[56:59], 0
    v_mfma_f32_32x32x16_bf16 v[216:231], v[116:119], v[28:31], v[216:231]
    v_mfma_f32_32x32x16_bf16 v[232:247], v[112:115], v[60:63], v[232:247]
    v_mfma_f32_32x32x16_bf16 v[216:231], v[132:135], v[32:35], v[216:231]
    v_mfma_f32_32x32x16_bf16 v[232:247], v[128:131], v[64:67], v[232:247]
    v_mfma_f32_32x32x16_bf16 v[216:231], v[148:151], v[36:39], v[216:231]
    v_mfma_f32_32x32x16_bf16 v[232:247], v[144:147], v[68:71], v[232:247]
    s_mov_b32 exec_hi, 0
    v_mov_b32 v184, 0
    v_mov_b32 v200, 0
    s_nop 8
    v_cvt_pk_bf16_f32 v22, v216, v232
    s_mov_b32 exec_hi, -1
K2A_NT:
    s_nop 7
    s_nop 1
    v_pk_add_f32 v[88:89], v[152:153], v[200:201] neg_lo:[0,1] neg_hi:[0,1]
    v_pk_add_f32 v[104:105], v[152:153], v[200:201]
    v_pk_add_f32 v[120:121], v[168:169], v[184:185] neg_lo:[0,1] neg_hi:[0,1]
    v_pk_add_f32 v[136:137], v[168:169], v[184:185]
    v_pk_add_f32 v[90:91], v[154:155], v[202:203] neg_lo:[0,1] neg_hi:[0,1]
    v_pk_add_f32 v[106:107], v[154:155], v[202:203]
    v_pk_add_f32 v[122:123], v[170:171], v[186:187] neg_lo:[0,1] neg_hi:[0,1]
    v_pk_add_f32 v[138:139], v[170:171], v[186:187]
    v_pk_add_f32 v[92:93], v[156:157], v[204:205] neg_lo:[0,1] neg_hi:[0,1]
    v_pk_add_f32 v[108:109], v[156:157], v[204:205]
    v_pk_add_f32 v[124:125], v[172:173], v[188:189] neg_lo:[0,1] neg_hi:[0,1]
    v_pk_add_f32 v[140:141], v[172:173], v[188:189]
    v_pk_add_f32 v[94:95], v[158:159], v[206:207] neg_lo:[0,1] neg_hi:[0,1]
    v_pk_add_f32 v[110:111], v[158:159], v[206:207]
    v_pk_add_f32 v[126:127], v[174:175], v[190:191] neg_lo:[0,1] neg_hi:[0,1]
    v_pk_add_f32 v[142:143], v[174:175], v[190:191]
    v_pk_add_f32 v[96:97], v[160:161], v[208:209] neg_lo:[0,1] neg_hi:[0,1]
    v_pk_add_f32 v[112:113], v[160:161], v[208:209]
    v_pk_add_f32 v[128:129], v[176:177], v[192:193] neg_lo:[0,1] neg_hi:[0,1]
    v_pk_add_f32 v[144:145], v[176:177], v[192:193]
    v_pk_add_f32 v[98:99], v[162:163], v[210:211] neg_lo:[0,1] neg_hi:[0,1]
    v_pk_add_f32 v[114:115], v[162:163], v[210:211]
    v_pk_add_f32 v[130:131], v[178:179], v[194:195] neg_lo:[0,1] neg_hi:[0,1]
    v_pk_add_f32 v[146:147], v[178:179], v[194:195]
    v_pk_add_f32 v[100:101], v[164:165], v[212:213] neg_lo:[0,1] neg_hi:[0,1]
    v_pk_add_f32 v[116:117], v[164:165], v[212:213]
    v_pk_add_f32 v[132:133], v[180:181], v[196:197] neg_lo:[0,1] neg_hi:[0,1]
    v_pk_add_f32 v[148:149], v[180:181], v[196:197]
    v_pk_add_f32 v[102:103], v[166:167], v[214:215] neg_lo:[0,1] neg_hi:[0,1]
    v_pk_add_f32 v[118:119], v[166:167], v[214:215]
    v_pk_add_f32 v[134:135], v[182:183], v[198:199] neg_lo:[0,1] neg_hi:[0,1]
    v_pk_add_f32 v[150:151], v[182:183], v[198:199]
    v_cvt_pk_bf16_f32 v152, v88, v89
    v_cvt_pk_bf16_f32 v153, v90, v91
    v_cvt_pk_bf16_f32 v154, v92, v93
    v_cvt_pk_bf16_f32 v155, v94, v95
    v_cvt_pk_bf16_f32 v156, v96, v97
    v_cvt_pk_bf16_f32 v157, v98, v99
    v_cvt_pk_bf16_f32 v158, v100, v101
    v_cvt_pk_bf16_f32 v159, v102, v103
    v_cvt_pk_bf16_f32 v160, v111, v104
    v_cvt_pk_bf16_f32 v161, v110, v109
    v_cvt_pk_bf16_f32 v162, v108, v107
    v_cvt_pk_bf16_f32 v163, v106, v105
    v_cvt_pk_bf16_f32 v164, v119, v112
    v_cvt_pk_bf16_f32 v165, v118, v117
    v_cvt_pk_bf16_f32 v166, v116, v115
    v_cvt_pk_bf16_f32 v167, v114, v113
    v_cvt_pk_bf16_f32 v168, v120, v121
    v_cvt_pk_bf16_f32 v169, v122, v123
    v_cvt_pk_bf16_f32 v170, v124, v125
    v_cvt_pk_bf16_f32 v171, v126, v127
    v_cvt_pk_bf16_f32 v172, v128, v129
    v_cvt_pk_bf16_f32 v173, v130, v131
    v_cvt_pk_bf16_f32 v174, v132, v133
    v_cvt_pk_bf16_f32 v175, v134, v135
    v_cvt_pk_bf16_f32 v176, v143, v136
    v_cvt_pk_bf16_f32 v177, v142, v141
    v_cvt_pk_bf16_f32 v178, v140, v139
    v_cvt_pk_bf16_f32 v179, v138, v137
    v_cvt_pk_bf16_f32 v180, v151, v144
    v_cvt_pk_bf16_f32 v181, v150, v149
    v_cvt_pk_bf16_f32 v182, v148, v147
    v_cvt_pk_bf16_f32 v183, v146, v145
K2A_C2:
    ds_write_b64 v12, v[152:153] offset:0
    ds_write_b64 v12, v[154:155] offset:8
    ds_write_b16 v13, v160 offset:32
    ds_write_b32 v13, v161 offset:34
    ds_write_b64 v13, v[162:163] offset:38
    ds_write_b16_d16_hi v13, v160 offset:46
    ds_write_b64 v12, v[156:157] offset:32
    ds_write_b64 v12, v[158:159] offset:40
    ds_write_b16 v13, v164 offset:0
    ds_write_b32 v13, v165 offset:2
    ds_write_b64 v13, v[166:167] offset:6
    ds_write_b16_d16_hi v13, v164 offset:14
    s_cmp_eq_u32 s40, 0
    s_cbranch_scc0 K2A_B2
    s_mov_b32 exec_hi, 0
    ds_write_b16 v12, v22 offset:448
    s_mov_b32 exec_hi, -1
K2A_B2:
    s_waitcnt lgkmcnt(0)
    s_barrier
    ds_read2_b64 v[24:27], v2 offset0:0 offset1:1
    ds_read2_b64 v[28:31], v2 offset0:113 offset1:114
    ds_read2_b64 v[32:35], v0 offset0:0 offset1:1
    ds_read2_b64 v[36:39], v0 offset0:113 offset1:114
    s_cmp_eq_u32 s40, 7
    s_cbranch_scc1 K2A_W7
    ds_write_b64 v20, v[168:169] offset:0
    ds_write_b64 v20, v[170:171] offset:8
    ds_write_b16 v21, v176 offset:32
    ds_write_b32 v21, v177 offset:34
    ds_write_b64 v21, v[178:179] offset:38
    ds_write_b16_d16_hi v21, v176 offset:46
    ds_write_b64 v20, v[172:173] offset:32
    ds_write_b64 v20, v[174:175] offset:40
    ds_write_b16 v21, v180 offset:0
    ds_write_b32 v21, v181 offset:2
    ds_write_b64 v21, v[182:183] offset:6
    ds_write_b16_d16_hi v21, v180 offset:14
    s_cmp_eq_u32 s40, 0
    s_cbranch_scc0 K2A_W7
    s_mov_b32 exec_hi, 0
    ds_write_b16_d16_hi v20, v22 offset:448
K2A_W7:
    s_mov_b32 exec_hi, 0x00ffffff
    s_waitcnt lgkmcnt(0)
    buffer_store_dwordx4 v[24:27], v15, s[28:31], s50 offen sc1
    s_add_u32 s50, s50, 57344
    buffer_store_dwordx4 v[28:31], v15, s[28:31], s50 offen sc1
    s_add_u32 s50, s50, 57344
    buffer_store_dwordx4 v[32:35], v15, s[28:31], s50 offen sc1
    s_add_u32 s50, s50, 57344
    buffer_store_dwordx4 v[36:39], v15, s[28:31], s50 offen sc1
    s_add_u32 s50, s50, 57344
    s_barrier
    ds_read2_b64 v[40:43], v4 offset0:0 offset1:1
    ds_read2_b64 v[44:47], v4 offset0:113 offset1:114
    ds_read2_b64 v[48:51], v5 offset0:0 offset1:1
    ds_read2_b64 v[52:55], v5 offset0:113 offset1:114
    s_waitcnt lgkmcnt(3)
    buffer_store_dwordx4 v[40:43], v15, s[28:31], s58 offen sc1
    s_add_u32 s58, s58, s53
    s_waitcnt lgkmcnt(2)
    buffer_store_dwordx4 v[44:47], v15, s[28:31], s58 offen sc1
    s_add_u32 s58, s58, s53
    s_waitcnt lgkmcnt(1)
    buffer_store_dwordx4 v[48:51], v15, s[28:31], s58 offen sc1
    s_add_u32 s58, s58, s53
    s_waitcnt lgkmcnt(0)
    buffer_store_dwordx4 v[52:55], v15, s[28:31], s58 offen sc1
    s_add_u32 s58, s58, s53
K2_END:
    s_endpgm
.section .rodata,"a"
.p2align 6
.amdhsa_kernel k1_kernel
  .amdhsa_next_free_vgpr 256
  .amdhsa_next_free_sgpr 102
  .amdhsa_accum_offset 256
  .amdhsa_group_segment_fixed_size 0
  .amdhsa_kernarg_size 96
  .amdhsa_user_sgpr_count 2
  .amdhsa_user_sgpr_kernarg_segment_ptr 1
  .amdhsa_system_sgpr_workgroup_id_x 1
.end_amdhsa_kernel
.p2align 6
.amdhsa_kernel k2_kernel
  .amdhsa_next_free_vgpr 256
  .amdhsa_next_free_sgpr 102
  .amdhsa_accum_offset 256
  .amdhsa_group_segment_fixed_size 0
  .amdhsa_kernarg_size 96
  .amdhsa_user_sgpr_count 2
  .amdhsa_user_sgpr_kernarg_segment_ptr 1
  .amdhsa_system_sgpr_workgroup_id_x 1
.end_amdhsa_kernel
```
